```python
import torch

def _softmax(x, axis=-1):
    return torch.softmax(x, dim=axis)
def _gelu(x):
    return torch.nn.functional.gelu(x, approximate="tanh")
def _silu(x):
    return torch.nn.functional.silu(x)
def _sigmoid(x):
    return torch.sigmoid(x)
def _layernorm(x, axis=-1, eps=1e-5):
    m = x.mean(dim=axis, keepdim=True)
    v = x.var(dim=axis, keepdim=True, unbiased=False)
    return (x - m) / torch.sqrt(v + eps)
def _scatter_add(tgt, idx, src, axis=0):
    return tgt.clone().index_add_(axis, idx, src)
def _segment_sum(src, seg, n):
    out = torch.zeros((n,) + src.shape[1:], dtype=src.dtype)
    return out.index_add_(0, seg, src)
def _pad(x, pw):
    flat = tuple(v for pair in reversed(pw) for v in pair)
    return torch.nn.functional.pad(x, flat)

kernel_name = 'concat_heads__mha_block_cached__gqa_block_cached__near_ridge'

def setup_inputs():

    _w = (lambda a: (lambda t: t.to(torch.bfloat16) if t.is_floating_point() else t)(torch.as_tensor(a)))
    def _A_setup():
        B, Sq, D = 32, 48, 448
        H, Sk, Dh = 16, 48, 256
        return {
            "x": _w((lambda *s: torch.randn(*s, dtype=torch.bfloat16) * 0.8)(B, Sq, D)),
            "k_cache": _w((lambda *s: torch.randn(*s, dtype=torch.bfloat16) * 0.8)(B, H, Sk, Dh)),
            "v_cache": _w((lambda *s: torch.randn(*s, dtype=torch.bfloat16) * 0.05)(B, H, Sk, Dh)),
            "wq": _w((lambda *s: torch.randn(*s, dtype=torch.bfloat16) * 0.8)(D, H * Dh) * (D ** -0.5)),
            "wo": _w((lambda *s: torch.randn(*s, dtype=torch.bfloat16) * 0.05)(H * Dh, D) * ((H * Dh) ** -0.5)),
        }
    _A_in = _A_setup()

    def _B_setup():
        B, Sq, D = 32, 48, 448
        Hq, Hkv, Sk, Dh = 16, 16, 48, 256
        assert Hq % Hkv == 0, (Hq, Hkv)
        return {
            "x": _w((lambda *s: torch.randn(*s, dtype=torch.bfloat16) * 0.8)(B, Sq, D)),
            "k_cache": _w((lambda *s: torch.randn(*s, dtype=torch.bfloat16) * 0.8)(B, Hkv, Sk, Dh)),
            "v_cache": _w((lambda *s: torch.randn(*s, dtype=torch.bfloat16) * 0.05)(B, Hkv, Sk, Dh)),
            "wq": _w((lambda *s: torch.randn(*s, dtype=torch.bfloat16) * 0.8)(D, Hq * Dh) * (D ** -0.5)),
            "wo": _w((lambda *s: torch.randn(*s, dtype=torch.bfloat16) * 0.05)(Hq * Dh, D) * ((Hq * Dh) ** -0.5)),
        }
    _B_in = _B_setup()

    return {
        "A_x": _A_in["x"],
        "A_k_cache": _A_in["k_cache"],
        "A_v_cache": _A_in["v_cache"],
        "A_wq": _A_in["wq"],
        "A_wo": _A_in["wo"],
        "B_x": _B_in["x"],
        "B_k_cache": _B_in["k_cache"],
        "B_v_cache": _B_in["v_cache"],
        "B_wq": _B_in["wq"],
        "B_wo": _B_in["wo"],
    }

def reference(A_x, A_k_cache, A_v_cache, A_wq, A_wo, B_x, B_k_cache, B_v_cache, B_wq, B_wo):
    def _A_ref(x, k_cache, v_cache, wq, wo):
        B, Sq, D = x.shape
        H, Dh = 16, 256
        q = (lambda x, *d: x.permute(*d))((x @ wq).reshape(B, Sq, H, Dh), 0, 2, 1, 3)
        scores = torch.einsum("bhqd,bhkd->bhqk", q, k_cache) * (Dh ** -0.5)
        p = _softmax(scores, axis=-1)
        o = torch.einsum("bhqk,bhkd->bhqd", p, v_cache)
        return (lambda x, *d: x.permute(*d))(o, 0, 2, 1, 3).reshape(B, Sq, H * Dh) @ wo

    def _B_ref(x, k_cache, v_cache, wq, wo):
        B, Sq, D = x.shape
        Hq, Dh = 16, 256
        Hkv = k_cache.shape[1]
        rep = Hq // Hkv
        q = (lambda x, *d: x.permute(*d))((x @ wq).reshape(B, Sq, Hq, Dh), 0, 2, 1, 3)
        k = (lambda x, n, axis: torch.repeat_interleave(x, n, dim=axis))(k_cache, rep, axis=1)
        v = (lambda x, n, axis: torch.repeat_interleave(x, n, dim=axis))(v_cache, rep, axis=1)
        scores = torch.einsum("bhqd,bhkd->bhqk", q, k) * (Dh ** -0.5)
        p = _softmax(scores, axis=-1)
        o = torch.einsum("bhqk,bhkd->bhqd", p, v)
        return (lambda x, *d: x.permute(*d))(o, 0, 2, 1, 3).reshape(B, Sq, Hq * Dh) @ wo

    a = _A_ref(A_x, A_k_cache, A_v_cache, A_wq, A_wo)
    b = _B_ref(B_x, B_k_cache, B_v_cache, B_wq, B_wo)
    return torch.concatenate([a, b], axis=-1)
```

```asm
; @launch grid=(256,1,1) block=(256,1,1) lds=163840
.amdgcn_target "amdgcn-amd-amdhsa--gfx950"
.text
.globl concat_heads__mha_block_cached__gqa_block_cached__near_ridge_kernel
.p2align 8
.type concat_heads__mha_block_cached__gqa_block_cached__near_ridge_kernel,@function
concat_heads__mha_block_cached__gqa_block_cached__near_ridge_kernel:
  s_cmp_ge_u32 s2, 256
  s_cbranch_scc1 Lend
  s_load_dwordx16 s[36:51], s[0:1], 0
  s_load_dwordx8 s[52:59], s[0:1], 64
  s_load_dwordx2 s[60:61], s[0:1], 96
  s_and_b32 s20, s2, 3
  s_bfe_u32 s21, s2, 0x10002
  s_bfe_u32 s22, s2, 0x20003
  s_lshr_b32 s23, s2, 5
  s_lshl_b32 s24, s20, 2
  s_add_u32 s24, s24, s22
  v_lshrrev_b32 v1, 6, v0
  s_nop 0
  v_readfirstlane_b32 s25, v1
  v_and_b32 v1, 63, v0
  s_lshl_b32 s26, s23, 2
  s_add_u32 s26, s26, s25
  s_mul_i32 s33, s25, 12288
  s_add_u32 s33, s33, 114688
  s_mul_i32 s31, s26, 43008
  v_lshrrev_b32 v64, 3, v1
  v_and_b32 v65, 7, v1
  v_lshrrev_b32 v66, 4, v1
  v_xor_b32 v65, v65, v66
  v_lshlrev_b32 v65, 4, v65
  v_mul_u32_u24 v64, 896, v64
  v_add3_u32 v22, v64, v65, s31
  v_xor_b32 v65, 64, v65
  v_add3_u32 v23, v64, v65, s31
  v_add_u32 v23, 6144, v23
  s_lshl_b32 s27, s25, 12
  s_and_b32 s31, s25, 1
  s_lshl_b32 s31, s31, 3
  s_lshl_b32 s32, s25, 16
  s_lshl_b32 s63, s24, 9
  s_add_u32 s32, s32, s63
  v_lshrrev_b32 v64, 5, v1
  v_and_b32 v65, 31, v1
  v_or_b32 v66, s31, v64
  v_xor_b32 v65, v65, v66
  v_lshlrev_b32 v65, 4, v65
  v_lshl_add_u32 v65, v64, 13, v65
  v_add_u32 v18, s32, v65
  v_xor_b32 v66, 64, v18
  v_add_u32 v19, 15360, v66
  v_add_u32 v20, 30720, v18
  v_add_u32 v21, 46080, v66
  v_and_b32 v64, 15, v1
  v_lshrrev_b32 v65, 4, v1
  v_lshrrev_b32 v66, 1, v64
  v_xor_b32 v66, v66, v65
  v_lshlrev_b32 v66, 4, v66
  v_lshl_add_u32 v66, v64, 7, v66
  v_add_u32 v26, s33, v66
  v_xor_b32 v66, 64, v66
  v_add_u32 v27, s33, v66
  s_mov_b32 s6, 1376256
  s_mov_b32 s7, 0x20000
  s_mov_b32 s10, 3670016
  s_mov_b32 s11, 0x20000
  s_mov_b32 s31, 0
  s_mov_b32 s32, 262144
  s_cmp_eq_u32 s21, 0
  s_waitcnt lgkmcnt(0)
  s_cselect_b64 s[4:5], s[36:37], s[46:47]
  s_cselect_b64 s[8:9], s[42:43], s[52:53]
  s_add_u32 m0, s33, 0
  s_mov_b32 s35, 0
  buffer_load_dwordx4 v22, s[4:7], s35 offen lds
  buffer_load_dwordx4 v23, s[4:7], s35 offen offset:1024 lds
  s_add_u32 m0, s33, 2048
  s_mov_b32 s35, 14336
  buffer_load_dwordx4 v22, s[4:7], s35 offen lds
  buffer_load_dwordx4 v23, s[4:7], s35 offen offset:1024 lds
  s_add_u32 m0, s33, 4096
  s_mov_b32 s35, 28672
  buffer_load_dwordx4 v22, s[4:7], s35 offen lds
  buffer_load_dwordx4 v23, s[4:7], s35 offen offset:1024 lds
  s_add_u32 m0, s27, 0
  s_nop 0
  buffer_load_dwordx4 v18, s[8:11], s31 offen offset:0 lds
  buffer_load_dwordx4 v19, s[8:11], s31 offen offset:1024 lds
  buffer_load_dwordx4 v20, s[8:11], s31 offen offset:2048 lds
  buffer_load_dwordx4 v21, s[8:11], s31 offen offset:3072 lds
  s_add_u32 m0, s27, 16384
  s_nop 0
  buffer_load_dwordx4 v18, s[8:11], s32 offen offset:0 lds
  buffer_load_dwordx4 v19, s[8:11], s32 offen offset:1024 lds
  buffer_load_dwordx4 v20, s[8:11], s32 offen offset:2048 lds
  s_waitcnt vmcnt(11)
  ds_read_b128 a[0:3], v26 offset:0
  ds_read_b128 a[12:15], v27 offset:0
  buffer_load_dwordx4 v21, s[8:11], s32 offen offset:3072 lds
  s_cmp_eq_u32 s21, 0
  s_cselect_b64 s[12:13], s[38:39], s[48:49]
  s_cselect_b64 s[64:65], s[40:41], s[50:51]
  s_cselect_b64 s[68:69], s[44:45], s[54:55]
  s_mov_b32 s14, 12582912
  s_mov_b32 s15, 0x20000
  s_mov_b32 s66, 12582912
  s_mov_b32 s67, 0x20000
  s_mov_b32 s70, 3670016
  s_mov_b32 s71, 0x20000
  s_mov_b32 s72, s56
  s_mov_b32 s73, s57
  s_mov_b32 s74, 2752512
  s_mov_b32 s75, 0x20000
  s_mov_b32 s16, s60
  s_mov_b32 s17, s61
  s_mov_b32 s18, 268435456
  s_mov_b32 s19, 0x20000
  s_mov_b32 s76, s58
  s_mov_b32 s77, s59
  s_mov_b32 s78, 256
  s_mov_b32 s79, 0x20000
  s_mov_b32 s90, 44040192
  buffer_load_dword v39, off, s[16:19], s90 sc1
  s_mov_b32 s51, 128
  s_mov_b32 s38, 524288
  s_mov_b32 s39, 786432
  s_add_u32 m0, s33, 6144
  s_add_u32 s35, s51, 0
  buffer_load_dwordx4 v22, s[4:7], s35 offen lds
  buffer_load_dwordx4 v23, s[4:7], s35 offen offset:1024 lds
  s_waitcnt vmcnt(13)
  ds_read_b128 a[4:7], v26 offset:2048
  ds_read_b128 a[16:19], v27 offset:2048
  s_add_u32 m0, s33, 8192
  s_add_u32 s35, s51, 14336
  buffer_load_dwordx4 v22, s[4:7], s35 offen lds
  buffer_load_dwordx4 v23, s[4:7], s35 offen offset:1024 lds
  s_waitcnt vmcnt(13)
  ds_read_b128 a[8:11], v26 offset:4096
  ds_read_b128 a[20:23], v27 offset:4096
  s_add_u32 m0, s33, 10240
  s_add_u32 s35, s51, 28672
  buffer_load_dwordx4 v22, s[4:7], s35 offen lds
  buffer_load_dwordx4 v23, s[4:7], s35 offen offset:1024 lds
  s_lshl_b32 s62, s22, 1
  s_add_u32 s62, s62, s23
  s_cmp_ge_u32 s62, 5
  s_cselect_b32 s63, 5, 0
  s_sub_u32 s62, s62, s63
  s_cmp_ge_u32 s62, 5
  s_cselect_b32 s63, 5, 0
  s_sub_u32 s62, s62, s63
  s_cmp_ge_u32 s62, 5
  s_cselect_b32 s63, 5, 0
  s_sub_u32 s62, s62, s63
  s_add_u32 s62, s62, 2
  s_lshl_b32 s52, s62, 7
  s_lshl_b32 s40, s62, 19
  s_add_u32 s41, s40, 262144
  s_add_u32 s62, s62, 1
  s_cmp_eq_u32 s62, 7
  s_cselect_b32 s62, 2, s62
  s_lshl_b32 s53, s62, 7
  s_lshl_b32 s42, s62, 19
  s_add_u32 s43, s42, 262144
  s_add_u32 s62, s62, 1
  s_cmp_eq_u32 s62, 7
  s_cselect_b32 s62, 2, s62
  s_lshl_b32 s54, s62, 7
  s_lshl_b32 s44, s62, 19
  s_add_u32 s45, s44, 262144
  s_add_u32 s62, s62, 1
  s_cmp_eq_u32 s62, 7
  s_cselect_b32 s62, 2, s62
  s_lshl_b32 s55, s62, 7
  s_lshl_b32 s46, s62, 19
  s_add_u32 s47, s46, 262144
  s_add_u32 s62, s62, 1
  s_cmp_eq_u32 s62, 7
  s_cselect_b32 s62, 2, s62
  s_lshl_b32 s56, s62, 7
  s_lshl_b32 s48, s62, 19
  s_add_u32 s49, s48, 262144
  v_lshrrev_b32 v64, 4, v1
  v_bfe_u32 v65, v1, 2, 2
  v_and_b32 v66, 3, v1
  v_lshl_add_u32 v67, v64, 3, v65
  v_lshlrev_b32 v67, 9, v67
  v_and_b32 v64, 1, v64
  v_lshlrev_b32 v64, 3, v64
  v_lshrrev_b32 v68, 1, v65
  v_lshl_or_b32 v64, v68, 2, v64
  v_and_b32 v65, 1, v65
  v_or_b32 v64, v64, v65
  v_xor_b32 v64, v64, v66
  v_lshl_add_u32 v67, v64, 4, v67
  v_and_b32 v66, 1, v66
  v_lshl_add_u32 v67, v66, 3, v67
  v_xor_b32 v2, 0, v67
  v_xor_b32 v10, 65536, v67
  v_xor_b32 v3, 8, v67
  v_xor_b32 v11, 65544, v67
  v_xor_b32 v4, 64, v67
  v_xor_b32 v12, 65600, v67
  v_xor_b32 v5, 72, v67
  v_xor_b32 v13, 65608, v67
  v_xor_b32 v6, 128, v67
  v_xor_b32 v14, 65664, v67
  v_xor_b32 v7, 136, v67
  v_xor_b32 v15, 65672, v67
  v_xor_b32 v8, 192, v67
  v_xor_b32 v16, 65728, v67
  v_xor_b32 v9, 200, v67
  v_xor_b32 v17, 65736, v67
  s_lshl_b32 s63, s26, 4
  s_add_u32 s62, s63, s24
  s_mul_i32 s35, s62, 24576
  v_lshrrev_b32 v64, 3, v1
  v_and_b32 v65, 7, v1
  v_lshrrev_b32 v66, 4, v1
  v_xor_b32 v65, v65, v66
  v_lshlrev_b32 v65, 4, v65
  v_mul_u32_u24 v64, 512, v64
  v_add3_u32 v24, v64, v65, s35
  v_xor_b32 v65, 64, v65
  v_add3_u32 v25, v64, v65, s35
  v_add_u32 v25, 3072, v25
  s_mul_i32 s35, s22, 24576
  v_subrev_u32 v28, s35, v24
  v_subrev_u32 v29, s35, v25
  s_lshl_b32 s63, s21, 9
  s_add_u32 s63, s63, s62
  s_mul_i32 s63, s63, 4608
  v_lshlrev_b32 v64, 4, v1
  v_add_u32 v37, s63, v64
  v_lshlrev_b32 v64, 3, v1
  s_add_u32 s63, s63, 1024
  v_add_u32 v38, s63, v64
  s_mov_b32 s28, 0xffff0000
  s_mov_b32 s29, 0xffff0000
  s_mov_b32 s30, 1035512379
  s_add_u32 s80, s23, 0
  s_and_b32 s80, s80, 3
  s_mov_b32 s84, 0
  s_add_u32 s81, s23, 1
  s_and_b32 s81, s81, 3
  s_mov_b32 s85, 128
  s_add_u32 s82, s23, 2
  s_and_b32 s82, s82, 3
  s_mov_b32 s86, 256
  s_add_u32 s83, s23, 3
  s_and_b32 s83, s83, 3
  s_mov_b32 s87, 384
  s_lshr_b32 s63, s25, 1
  s_add_u32 s63, s63, 0
  s_and_b32 s63, s63, 3
  s_lshl_b32 s63, s63, 1
  s_and_b32 s35, s25, 1
  s_add_u32 s63, s63, s35
  s_mul_i32 s88, s63, 28672
  s_lshr_b32 s63, s25, 1
  s_add_u32 s63, s63, 2
  s_and_b32 s63, s63, 3
  s_lshl_b32 s63, s63, 1
  s_and_b32 s35, s25, 1
  s_add_u32 s63, s63, s35
  s_mul_i32 s89, s63, 28672
  s_mul_i32 s34, s25, 7168
  s_mul_i32 s63, s22, 224
  s_mul_i32 s35, s20, 917504
  s_add_u32 s63, s63, s35
  s_mov_b32 s35, 306783379
  v_add_u32 v64, 0, v1
  v_mul_hi_u32 v65, v64, s35
  v_mul_u32_u24 v66, 14, v65
  v_sub_u32 v66, v64, v66
  v_and_b32 v64, 19, v65
  v_bfe_u32 v67, v65, 2, 1
  v_lshl_or_b32 v64, v67, 3, v64
  v_bfe_u32 v67, v65, 3, 1
  v_lshl_or_b32 v64, v67, 2, v64
  v_mul_u32_u24 v64, 896, v64
  v_lshl_add_u32 v64, v66, 4, v64
  v_add_u32 v30, s63, v64
  v_add_u32 v64, 64, v1
  v_mul_hi_u32 v65, v64, s35
  v_mul_u32_u24 v66, 14, v65
  v_sub_u32 v66, v64, v66
  v_and_b32 v64, 19, v65
  v_bfe_u32 v67, v65, 2, 1
  v_lshl_or_b32 v64, v67, 3, v64
  v_bfe_u32 v67, v65, 3, 1
  v_lshl_or_b32 v64, v67, 2, v64
  v_mul_u32_u24 v64, 896, v64
  v_lshl_add_u32 v64, v66, 4, v64
  v_add_u32 v31, s63, v64
  v_subrev_u32 v31, 1024, v31
  v_add_u32 v64, 128, v1
  v_mul_hi_u32 v65, v64, s35
  v_mul_u32_u24 v66, 14, v65
  v_sub_u32 v66, v64, v66
  v_and_b32 v64, 19, v65
  v_bfe_u32 v67, v65, 2, 1
  v_lshl_or_b32 v64, v67, 3, v64
  v_bfe_u32 v67, v65, 3, 1
  v_lshl_or_b32 v64, v67, 2, v64
  v_mul_u32_u24 v64, 896, v64
  v_lshl_add_u32 v64, v66, 4, v64
  v_add_u32 v32, s63, v64
  v_subrev_u32 v32, 2048, v32
  v_add_u32 v64, 192, v1
  v_mul_hi_u32 v65, v64, s35
  v_mul_u32_u24 v66, 14, v65
  v_sub_u32 v66, v64, v66
  v_and_b32 v64, 19, v65
  v_bfe_u32 v67, v65, 2, 1
  v_lshl_or_b32 v64, v67, 3, v64
  v_bfe_u32 v67, v65, 3, 1
  v_lshl_or_b32 v64, v67, 2, v64
  v_mul_u32_u24 v64, 896, v64
  v_lshl_add_u32 v64, v66, 4, v64
  v_add_u32 v33, s63, v64
  v_subrev_u32 v33, 3072, v33
  v_add_u32 v64, 256, v1
  v_mul_hi_u32 v65, v64, s35
  v_mul_u32_u24 v66, 14, v65
  v_sub_u32 v66, v64, v66
  v_and_b32 v64, 19, v65
  v_bfe_u32 v67, v65, 2, 1
  v_lshl_or_b32 v64, v67, 3, v64
  v_bfe_u32 v67, v65, 3, 1
  v_lshl_or_b32 v64, v67, 2, v64
  v_mul_u32_u24 v64, 896, v64
  v_lshl_add_u32 v64, v66, 4, v64
  v_add_u32 v34, s63, v64
  v_add_u32 v64, 320, v1
  v_mul_hi_u32 v65, v64, s35
  v_mul_u32_u24 v66, 14, v65
  v_sub_u32 v66, v64, v66
  v_and_b32 v64, 19, v65
  v_bfe_u32 v67, v65, 2, 1
  v_lshl_or_b32 v64, v67, 3, v64
  v_bfe_u32 v67, v65, 3, 1
  v_lshl_or_b32 v64, v67, 2, v64
  v_mul_u32_u24 v64, 896, v64
  v_lshl_add_u32 v64, v66, 4, v64
  v_add_u32 v35, s63, v64
  v_subrev_u32 v35, 1024, v35
  v_add_u32 v64, 384, v1
  v_mul_hi_u32 v65, v64, s35
  v_mul_u32_u24 v66, 14, v65
  v_sub_u32 v66, v64, v66
  v_and_b32 v64, 19, v65
  v_bfe_u32 v67, v65, 2, 1
  v_lshl_or_b32 v64, v67, 3, v64
  v_bfe_u32 v67, v65, 3, 1
  v_lshl_or_b32 v64, v67, 2, v64
  v_mul_u32_u24 v64, 896, v64
  v_lshl_add_u32 v64, v66, 4, v64
  v_add_u32 v36, s63, v64
  v_subrev_u32 v36, 2048, v36
  s_add_u32 m0, s27, 32768
  s_nop 0
  buffer_load_dwordx4 v18, s[8:11], s38 offen offset:0 lds
  buffer_load_dwordx4 v19, s[8:11], s38 offen offset:1024 lds
  s_waitcnt vmcnt(13)
  s_barrier
  ds_read_b64_tr_b16 v[40:41], v2 offset:0
  ds_read_b64_tr_b16 v[42:43], v2 offset:2048
  ds_read_b64_tr_b16 v[44:45], v3 offset:0
  ds_read_b64_tr_b16 v[46:47], v3 offset:2048
  ds_read_b64_tr_b16 v[48:49], v4 offset:0
  ds_read_b64_tr_b16 v[50:51], v4 offset:2048
  ds_read_b64_tr_b16 v[52:53], v5 offset:0
  ds_read_b64_tr_b16 v[54:55], v5 offset:2048
  s_waitcnt lgkmcnt(6)
  v_mfma_f32_16x16x32_bf16 v[64:67], v[40:43], a[0:3], 0
  ds_read_b64_tr_b16 v[56:57], v6 offset:0
  buffer_load_dwordx4 v20, s[8:11], s38 offen offset:2048 lds
  v_mfma_f32_16x16x32_bf16 v[68:71], v[40:43], a[4:7], 0
  ds_read_b64_tr_b16 v[58:59], v6 offset:2048
  v_mfma_f32_16x16x32_bf16 v[72:75], v[40:43], a[8:11], 0
  s_waitcnt lgkmcnt(6)
  v_mfma_f32_16x16x32_bf16 v[76:79], v[44:47], a[0:3], 0
  ds_read_b64_tr_b16 v[60:61], v7 offset:0
  v_mfma_f32_16x16x32_bf16 v[80:83], v[44:47], a[4:7], 0
  ds_read_b64_tr_b16 v[62:63], v7 offset:2048
  v_mfma_f32_16x16x32_bf16 v[84:87], v[44:47], a[8:11], 0
  s_waitcnt lgkmcnt(4)
  buffer_load_dwordx4 v21, s[8:11], s38 offen offset:3072 lds
  v_mfma_f32_16x16x32_bf16 v[88:91], v[48:51], a[0:3], 0
  ds_read_b64_tr_b16 v[40:41], v8 offset:0
  v_mfma_f32_16x16x32_bf16 v[92:95], v[48:51], a[4:7], 0
  ds_read_b64_tr_b16 v[42:43], v8 offset:2048
  v_mfma_f32_16x16x32_bf16 v[96:99], v[48:51], a[8:11], 0
  v_mfma_f32_16x16x32_bf16 v[100:103], v[52:55], a[0:3], 0
  ds_read_b64_tr_b16 v[44:45], v9 offset:0
  v_mfma_f32_16x16x32_bf16 v[104:107], v[52:55], a[4:7], 0
  ds_read_b64_tr_b16 v[46:47], v9 offset:2048
  s_add_u32 m0, s27, 49152
  v_mfma_f32_16x16x32_bf16 v[108:111], v[52:55], a[8:11], 0
  s_waitcnt lgkmcnt(4)
  s_nop 0
  v_mfma_f32_16x16x32_bf16 v[112:115], v[56:59], a[0:3], 0
  ds_read_b64_tr_b16 v[48:49], v2 offset:256
  buffer_load_dwordx4 v18, s[8:11], s39 offen offset:0 lds
  v_mfma_f32_16x16x32_bf16 v[116:119], v[56:59], a[4:7], 0
  ds_read_b64_tr_b16 v[50:51], v2 offset:2304
  v_mfma_f32_16x16x32_bf16 v[120:123], v[56:59], a[8:11], 0
  v_mfma_f32_16x16x32_bf16 v[124:127], v[60:63], a[0:3], 0
  ds_read_b64_tr_b16 v[52:53], v3 offset:256
  buffer_load_dwordx4 v19, s[8:11], s39 offen offset:1024 lds
  v_mfma_f32_16x16x32_bf16 v[128:131], v[60:63], a[4:7], 0
  ds_read_b64_tr_b16 v[54:55], v3 offset:2304
  v_mfma_f32_16x16x32_bf16 v[132:135], v[60:63], a[8:11], 0
  s_waitcnt lgkmcnt(4)
  v_mfma_f32_16x16x32_bf16 v[136:139], v[40:43], a[0:3], 0
  ds_read_b64_tr_b16 v[56:57], v4 offset:256
  v_mfma_f32_16x16x32_bf16 v[140:143], v[40:43], a[4:7], 0
  ds_read_b64_tr_b16 v[58:59], v4 offset:2304
  v_mfma_f32_16x16x32_bf16 v[144:147], v[40:43], a[8:11], 0
  buffer_load_dwordx4 v20, s[8:11], s39 offen offset:2048 lds
  v_mfma_f32_16x16x32_bf16 v[148:151], v[44:47], a[0:3], 0
  ds_read_b64_tr_b16 v[60:61], v5 offset:256
  v_mfma_f32_16x16x32_bf16 v[152:155], v[44:47], a[4:7], 0
  ds_read_b64_tr_b16 v[62:63], v5 offset:2304
  v_mfma_f32_16x16x32_bf16 v[156:159], v[44:47], a[8:11], 0
  s_waitcnt lgkmcnt(4)
  v_mfma_f32_16x16x32_bf16 v[160:163], v[48:51], a[0:3], 0
  ds_read_b64_tr_b16 v[40:41], v6 offset:256
  v_mfma_f32_16x16x32_bf16 v[164:167], v[48:51], a[4:7], 0
  ds_read_b64_tr_b16 v[42:43], v6 offset:2304
  s_waitcnt vmcnt(11)
  v_mfma_f32_16x16x32_bf16 v[168:171], v[48:51], a[8:11], 0
  ds_read_b128 a[24:27], v26 offset:6144
  v_mfma_f32_16x16x32_bf16 v[172:175], v[52:55], a[0:3], 0
  ds_read_b64_tr_b16 v[44:45], v7 offset:256
  v_mfma_f32_16x16x32_bf16 v[176:179], v[52:55], a[4:7], 0
  ds_read_b64_tr_b16 v[46:47], v7 offset:2304
  ds_read_b128 a[36:39], v27 offset:6144
  v_mfma_f32_16x16x32_bf16 v[180:183], v[52:55], a[8:11], 0
  s_waitcnt lgkmcnt(6)
  buffer_load_dwordx4 v21, s[8:11], s39 offen offset:3072 lds
  v_mfma_f32_16x16x32_bf16 v[184:187], v[56:59], a[0:3], 0
  ds_read_b64_tr_b16 v[48:49], v8 offset:256
  v_mfma_f32_16x16x32_bf16 v[188:191], v[56:59], a[4:7], 0
  ds_read_b64_tr_b16 v[50:51], v8 offset:2304
  s_barrier
  v_mfma_f32_16x16x32_bf16 v[192:195], v[56:59], a[8:11], 0
  s_add_u32 m0, s33, 0
  v_mfma_f32_16x16x32_bf16 v[196:199], v[60:63], a[0:3], 0
  ds_read_b64_tr_b16 v[52:53], v9 offset:256
  s_add_u32 s35, s52, 0
  v_mfma_f32_16x16x32_bf16 v[200:203], v[60:63], a[4:7], 0
  ds_read_b64_tr_b16 v[54:55], v9 offset:2304
  buffer_load_dwordx4 v22, s[4:7], s35 offen lds
  v_mfma_f32_16x16x32_bf16 v[204:207], v[60:63], a[8:11], 0
  s_waitcnt lgkmcnt(5)
  buffer_load_dwordx4 v23, s[4:7], s35 offen offset:1024 lds
  v_mfma_f32_16x16x32_bf16 v[208:211], v[40:43], a[0:3], 0
  ds_read_b64_tr_b16 v[56:57], v2 offset:16384
  s_waitcnt vmcnt(12)
  v_mfma_f32_16x16x32_bf16 v[212:215], v[40:43], a[4:7], 0
  ds_read_b64_tr_b16 v[58:59], v2 offset:18432
  v_mfma_f32_16x16x32_bf16 v[216:219], v[40:43], a[8:11], 0
  ds_read_b128 a[28:31], v26 offset:8192
  ds_read_b128 a[40:43], v27 offset:8192
  v_mfma_f32_16x16x32_bf16 v[220:223], v[44:47], a[0:3], 0
  ds_read_b64_tr_b16 v[60:61], v3 offset:16384
  v_mfma_f32_16x16x32_bf16 v[224:227], v[44:47], a[4:7], 0
  ds_read_b64_tr_b16 v[62:63], v3 offset:18432
  v_mfma_f32_16x16x32_bf16 v[228:231], v[44:47], a[8:11], 0
  s_waitcnt lgkmcnt(6)
  s_add_u32 m0, s33, 2048
  v_mfma_f32_16x16x32_bf16 v[232:235], v[48:51], a[0:3], 0
  ds_read_b64_tr_b16 v[40:41], v4 offset:16384
  s_add_u32 s35, s52, 14336
  v_mfma_f32_16x16x32_bf16 v[236:239], v[48:51], a[4:7], 0
  ds_read_b64_tr_b16 v[42:43], v4 offset:18432
  buffer_load_dwordx4 v22, s[4:7], s35 offen lds
  v_mfma_f32_16x16x32_bf16 v[240:243], v[48:51], a[8:11], 0
  buffer_load_dwordx4 v23, s[4:7], s35 offen offset:1024 lds
  v_mfma_f32_16x16x32_bf16 v[244:247], v[52:55], a[0:3], 0
  ds_read_b64_tr_b16 v[44:45], v5 offset:16384
  s_waitcnt vmcnt(12)
  v_mfma_f32_16x16x32_bf16 v[248:251], v[52:55], a[4:7], 0
  ds_read_b64_tr_b16 v[46:47], v5 offset:18432
  v_mfma_f32_16x16x32_bf16 v[252:255], v[52:55], a[8:11], 0
  s_waitcnt lgkmcnt(4)
  ds_read_b128 a[32:35], v26 offset:10240
  v_mfma_f32_16x16x32_bf16 v[64:67], v[56:59], a[12:15], v[64:67]
  ds_read_b64_tr_b16 v[48:49], v6 offset:16384
  ds_read_b128 a[44:47], v27 offset:10240
  v_mfma_f32_16x16x32_bf16 v[68:71], v[56:59], a[16:19], v[68:71]
  ds_read_b64_tr_b16 v[50:51], v6 offset:18432
  s_waitcnt vmcnt(8)
  v_mfma_f32_16x16x32_bf16 v[72:75], v[56:59], a[20:23], v[72:75]
  s_barrier
  v_mfma_f32_16x16x32_bf16 v[76:79], v[60:63], a[12:15], v[76:79]
  ds_read_b64_tr_b16 v[52:53], v7 offset:16384
  s_add_u32 m0, s33, 4096
  v_mfma_f32_16x16x32_bf16 v[80:83], v[60:63], a[16:19], v[80:83]
  ds_read_b64_tr_b16 v[54:55], v7 offset:18432
  s_add_u32 s35, s52, 28672
  v_mfma_f32_16x16x32_bf16 v[84:87], v[60:63], a[20:23], v[84:87]
  s_waitcnt lgkmcnt(6)
  buffer_load_dwordx4 v22, s[4:7], s35 offen lds
  v_mfma_f32_16x16x32_bf16 v[88:91], v[40:43], a[12:15], v[88:91]
  ds_read_b64_tr_b16 v[56:57], v8 offset:16384
  buffer_load_dwordx4 v23, s[4:7], s35 offen offset:1024 lds
  v_mfma_f32_16x16x32_bf16 v[92:95], v[40:43], a[16:19], v[92:95]
  ds_read_b64_tr_b16 v[58:59], v8 offset:18432
  v_mfma_f32_16x16x32_bf16 v[96:99], v[40:43], a[20:23], v[96:99]
  v_mfma_f32_16x16x32_bf16 v[100:103], v[44:47], a[12:15], v[100:103]
  ds_read_b64_tr_b16 v[60:61], v9 offset:16384
  v_mfma_f32_16x16x32_bf16 v[104:107], v[44:47], a[16:19], v[104:107]
  ds_read_b64_tr_b16 v[62:63], v9 offset:18432
  v_mfma_f32_16x16x32_bf16 v[108:111], v[44:47], a[20:23], v[108:111]
  s_waitcnt lgkmcnt(4)
  v_mfma_f32_16x16x32_bf16 v[112:115], v[48:51], a[12:15], v[112:115]
  ds_read_b64_tr_b16 v[40:41], v2 offset:16640
  s_add_u32 m0, s27, 65536
  v_mfma_f32_16x16x32_bf16 v[116:119], v[48:51], a[16:19], v[116:119]
  ds_read_b64_tr_b16 v[42:43], v2 offset:18688
  s_nop 0
  v_mfma_f32_16x16x32_bf16 v[120:123], v[48:51], a[20:23], v[120:123]
  buffer_load_dwordx4 v18, s[8:11], s40 offen offset:0 lds
  v_mfma_f32_16x16x32_bf16 v[124:127], v[52:55], a[12:15], v[124:127]
  ds_read_b64_tr_b16 v[44:45], v3 offset:16640
  v_mfma_f32_16x16x32_bf16 v[128:131], v[52:55], a[16:19], v[128:131]
  ds_read_b64_tr_b16 v[46:47], v3 offset:18688
  v_mfma_f32_16x16x32_bf16 v[132:135], v[52:55], a[20:23], v[132:135]
  s_waitcnt lgkmcnt(4)
  buffer_load_dwordx4 v19, s[8:11], s40 offen offset:1024 lds
  v_mfma_f32_16x16x32_bf16 v[136:139], v[56:59], a[12:15], v[136:139]
  ds_read_b64_tr_b16 v[48:49], v4 offset:16640
  v_mfma_f32_16x16x32_bf16 v[140:143], v[56:59], a[16:19], v[140:143]
  ds_read_b64_tr_b16 v[50:51], v4 offset:18688
  v_mfma_f32_16x16x32_bf16 v[144:147], v[56:59], a[20:23], v[144:147]
  v_mfma_f32_16x16x32_bf16 v[148:151], v[60:63], a[12:15], v[148:151]
  ds_read_b64_tr_b16 v[52:53], v5 offset:16640
  v_mfma_f32_16x16x32_bf16 v[152:155], v[60:63], a[16:19], v[152:155]
  ds_read_b64_tr_b16 v[54:55], v5 offset:18688
  v_mfma_f32_16x16x32_bf16 v[156:159], v[60:63], a[20:23], v[156:159]
  s_waitcnt lgkmcnt(4)
  v_add_u32 v39, 1, v39
  v_or_b32 v39, 0x80000000, v39
  s_or_b32 s63, s2, s25
  s_cmp_lg_u32 s63, 0
  s_cbranch_scc1 Lnotag
  s_mov_b32 s63, 44040192
  s_mov_b64 exec, 1
  buffer_store_dword v39, off, s[16:19], s63 sc1
  buffer_store_dword v39, off, s[76:79], 0 sc1
  s_mov_b64 exec, -1
  s_nop 1
Lnotag:
  v_mfma_f32_16x16x32_bf16 v[160:163], v[40:43], a[12:15], v[160:163]
  ds_read_b64_tr_b16 v[56:57], v6 offset:16640
  buffer_load_dwordx4 v20, s[8:11], s40 offen offset:2048 lds
  v_mfma_f32_16x16x32_bf16 v[164:167], v[40:43], a[16:19], v[164:167]
  ds_read_b64_tr_b16 v[58:59], v6 offset:18688
  v_mfma_f32_16x16x32_bf16 v[168:171], v[40:43], a[20:23], v[168:171]
  v_mfma_f32_16x16x32_bf16 v[172:175], v[44:47], a[12:15], v[172:175]
  ds_read_b64_tr_b16 v[60:61], v7 offset:16640
  buffer_load_dwordx4 v21, s[8:11], s40 offen offset:3072 lds
  v_mfma_f32_16x16x32_bf16 v[176:179], v[44:47], a[16:19], v[176:179]
  ds_read_b64_tr_b16 v[62:63], v7 offset:18688
  v_mfma_f32_16x16x32_bf16 v[180:183], v[44:47], a[20:23], v[180:183]
  s_waitcnt lgkmcnt(4)
  v_mfma_f32_16x16x32_bf16 v[184:187], v[48:51], a[12:15], v[184:187]
  ds_read_b64_tr_b16 v[40:41], v8 offset:16640
  v_mfma_f32_16x16x32_bf16 v[188:191], v[48:51], a[16:19], v[188:191]
  ds_read_b64_tr_b16 v[42:43], v8 offset:18688
  v_mfma_f32_16x16x32_bf16 v[192:195], v[48:51], a[20:23], v[192:195]
  s_add_u32 m0, s27, 81920
  s_nop 0
  v_mfma_f32_16x16x32_bf16 v[196:199], v[52:55], a[12:15], v[196:199]
  ds_read_b64_tr_b16 v[44:45], v9 offset:16640
  buffer_load_dwordx4 v18, s[8:11], s41 offen offset:0 lds
  v_mfma_f32_16x16x32_bf16 v[200:203], v[52:55], a[16:19], v[200:203]
  ds_read_b64_tr_b16 v[46:47], v9 offset:18688
  v_mfma_f32_16x16x32_bf16 v[204:207], v[52:55], a[20:23], v[204:207]
  s_waitcnt lgkmcnt(4)
  v_mfma_f32_16x16x32_bf16 v[208:211], v[56:59], a[12:15], v[208:211]
  ds_read_b64_tr_b16 v[48:49], v2 offset:32768
  v_mfma_f32_16x16x32_bf16 v[212:215], v[56:59], a[16:19], v[212:215]
  ds_read_b64_tr_b16 v[50:51], v2 offset:34816
  buffer_load_dwordx4 v19, s[8:11], s41 offen offset:1024 lds
  v_mfma_f32_16x16x32_bf16 v[216:219], v[56:59], a[20:23], v[216:219]
  v_mfma_f32_16x16x32_bf16 v[220:223], v[60:63], a[12:15], v[220:223]
  ds_read_b64_tr_b16 v[52:53], v3 offset:32768
  v_mfma_f32_16x16x32_bf16 v[224:227], v[60:63], a[16:19], v[224:227]
  ds_read_b64_tr_b16 v[54:55], v3 offset:34816
  v_mfma_f32_16x16x32_bf16 v[228:231], v[60:63], a[20:23], v[228:231]
  s_waitcnt lgkmcnt(4)
  v_mfma_f32_16x16x32_bf16 v[232:235], v[40:43], a[12:15], v[232:235]
  ds_read_b64_tr_b16 v[56:57], v4 offset:32768
  buffer_load_dwordx4 v20, s[8:11], s41 offen offset:2048 lds
  v_mfma_f32_16x16x32_bf16 v[236:239], v[40:43], a[16:19], v[236:239]
  ds_read_b64_tr_b16 v[58:59], v4 offset:34816
  v_mfma_f32_16x16x32_bf16 v[240:243], v[40:43], a[20:23], v[240:243]
  v_mfma_f32_16x16x32_bf16 v[244:247], v[44:47], a[12:15], v[244:247]
  ds_read_b64_tr_b16 v[60:61], v5 offset:32768
  v_mfma_f32_16x16x32_bf16 v[248:251], v[44:47], a[16:19], v[248:251]
  ds_read_b64_tr_b16 v[62:63], v5 offset:34816
  v_mfma_f32_16x16x32_bf16 v[252:255], v[44:47], a[20:23], v[252:255]
  s_waitcnt lgkmcnt(4)
  s_waitcnt vmcnt(13)
  v_mfma_f32_16x16x32_bf16 v[64:67], v[48:51], a[24:27], v[64:67]
  ds_read_b64_tr_b16 v[40:41], v6 offset:32768
  s_barrier
  v_mfma_f32_16x16x32_bf16 v[68:71], v[48:51], a[28:31], v[68:71]
  ds_read_b64_tr_b16 v[42:43], v6 offset:34816
  s_waitcnt vmcnt(11)
  v_mfma_f32_16x16x32_bf16 v[72:75], v[48:51], a[32:35], v[72:75]
  ds_read_b128 a[48:51], v26 offset:0
  ds_read_b128 a[60:63], v27 offset:0
  v_mfma_f32_16x16x32_bf16 v[76:79], v[52:55], a[24:27], v[76:79]
  ds_read_b64_tr_b16 v[44:45], v7 offset:32768
  buffer_load_dwordx4 v21, s[8:11], s41 offen offset:3072 lds
  v_mfma_f32_16x16x32_bf16 v[80:83], v[52:55], a[28:31], v[80:83]
  ds_read_b64_tr_b16 v[46:47], v7 offset:34816
  s_add_u32 m0, s27, 98304
  v_mfma_f32_16x16x32_bf16 v[84:87], v[52:55], a[32:35], v[84:87]
  s_waitcnt lgkmcnt(6)
  s_nop 0
  v_mfma_f32_16x16x32_bf16 v[88:91], v[56:59], a[24:27], v[88:91]
  ds_read_b64_tr_b16 v[48:49], v8 offset:32768
  buffer_load_dwordx4 v18, s[8:11], s42 offen offset:0 lds
  v_mfma_f32_16x16x32_bf16 v[92:95], v[56:59], a[28:31], v[92:95]
  ds_read_b64_tr_b16 v[50:51], v8 offset:34816
  v_mfma_f32_16x16x32_bf16 v[96:99], v[56:59], a[32:35], v[96:99]
  buffer_load_dwordx4 v19, s[8:11], s42 offen offset:1024 lds
  v_mfma_f32_16x16x32_bf16 v[100:103], v[60:63], a[24:27], v[100:103]
  ds_read_b64_tr_b16 v[52:53], v9 offset:32768
  s_waitcnt vmcnt(12)
  v_mfma_f32_16x16x32_bf16 v[104:107], v[60:63], a[28:31], v[104:107]
  ds_read_b64_tr_b16 v[54:55], v9 offset:34816
  v_mfma_f32_16x16x32_bf16 v[108:111], v[60:63], a[32:35], v[108:111]
  s_waitcnt lgkmcnt(4)
  ds_read_b128 a[52:55], v26 offset:2048
  v_mfma_f32_16x16x32_bf16 v[112:115], v[40:43], a[24:27], v[112:115]
  ds_read_b64_tr_b16 v[56:57], v2 offset:33024
  ds_read_b128 a[64:67], v27 offset:2048
  v_mfma_f32_16x16x32_bf16 v[116:119], v[40:43], a[28:31], v[116:119]
  ds_read_b64_tr_b16 v[58:59], v2 offset:35072
  buffer_load_dwordx4 v20, s[8:11], s42 offen offset:2048 lds
  v_mfma_f32_16x16x32_bf16 v[120:123], v[40:43], a[32:35], v[120:123]
  v_mfma_f32_16x16x32_bf16 v[124:127], v[44:47], a[24:27], v[124:127]
  ds_read_b64_tr_b16 v[60:61], v3 offset:33024
  v_mfma_f32_16x16x32_bf16 v[128:131], v[44:47], a[28:31], v[128:131]
  ds_read_b64_tr_b16 v[62:63], v3 offset:35072
  buffer_load_dwordx4 v21, s[8:11], s42 offen offset:3072 lds
  v_mfma_f32_16x16x32_bf16 v[132:135], v[44:47], a[32:35], v[132:135]
  s_waitcnt lgkmcnt(6)
  v_mfma_f32_16x16x32_bf16 v[136:139], v[48:51], a[24:27], v[136:139]
  ds_read_b64_tr_b16 v[40:41], v4 offset:33024
  v_mfma_f32_16x16x32_bf16 v[140:143], v[48:51], a[28:31], v[140:143]
  ds_read_b64_tr_b16 v[42:43], v4 offset:35072
  s_waitcnt vmcnt(12)
  v_mfma_f32_16x16x32_bf16 v[144:147], v[48:51], a[32:35], v[144:147]
  ds_read_b128 a[56:59], v26 offset:4096
  v_mfma_f32_16x16x32_bf16 v[148:151], v[52:55], a[24:27], v[148:151]
  ds_read_b64_tr_b16 v[44:45], v5 offset:33024
  v_mfma_f32_16x16x32_bf16 v[152:155], v[52:55], a[28:31], v[152:155]
  ds_read_b64_tr_b16 v[46:47], v5 offset:35072
  ds_read_b128 a[68:71], v27 offset:4096
  v_mfma_f32_16x16x32_bf16 v[156:159], v[52:55], a[32:35], v[156:159]
  s_waitcnt lgkmcnt(6)
  v_mfma_f32_16x16x32_bf16 v[160:163], v[56:59], a[24:27], v[160:163]
  ds_read_b64_tr_b16 v[48:49], v6 offset:33024
  s_add_u32 m0, s33, 6144
  v_mfma_f32_16x16x32_bf16 v[164:167], v[56:59], a[28:31], v[164:167]
  ds_read_b64_tr_b16 v[50:51], v6 offset:35072
  s_mov_b32 s35, 0
  v_mfma_f32_16x16x32_bf16 v[168:171], v[56:59], a[32:35], v[168:171]
  buffer_load_dwordx4 v24, s[12:15], s35 offen nt lds
  buffer_load_dwordx4 v25, s[12:15], s35 offen offset:1024 nt lds
  v_mfma_f32_16x16x32_bf16 v[172:175], v[60:63], a[24:27], v[172:175]
  ds_read_b64_tr_b16 v[52:53], v7 offset:33024
  v_mfma_f32_16x16x32_bf16 v[176:179], v[60:63], a[28:31], v[176:179]
  ds_read_b64_tr_b16 v[54:55], v7 offset:35072
  v_mfma_f32_16x16x32_bf16 v[180:183], v[60:63], a[32:35], v[180:183]
  s_waitcnt lgkmcnt(5)
  v_mfma_f32_16x16x32_bf16 v[184:187], v[40:43], a[24:27], v[184:187]
  ds_read_b64_tr_b16 v[56:57], v8 offset:33024
  v_mfma_f32_16x16x32_bf16 v[188:191], v[40:43], a[28:31], v[188:191]
  ds_read_b64_tr_b16 v[58:59], v8 offset:35072
  s_add_u32 m0, s33, 8192
  v_mfma_f32_16x16x32_bf16 v[192:195], v[40:43], a[32:35], v[192:195]
  s_mov_b32 s35, 8192
  buffer_load_dwordx4 v24, s[12:15], s35 offen nt lds
  v_mfma_f32_16x16x32_bf16 v[196:199], v[44:47], a[24:27], v[196:199]
  ds_read_b64_tr_b16 v[60:61], v9 offset:33024
  buffer_load_dwordx4 v25, s[12:15], s35 offen offset:1024 nt lds
  v_mfma_f32_16x16x32_bf16 v[200:203], v[44:47], a[28:31], v[200:203]
  ds_read_b64_tr_b16 v[62:63], v9 offset:35072
  v_mfma_f32_16x16x32_bf16 v[204:207], v[44:47], a[32:35], v[204:207]
  s_waitcnt lgkmcnt(4)
  v_mfma_f32_16x16x32_bf16 v[208:211], v[48:51], a[24:27], v[208:211]
  ds_read_b64_tr_b16 v[40:41], v2 offset:49152
  v_mfma_f32_16x16x32_bf16 v[212:215], v[48:51], a[28:31], v[212:215]
  ds_read_b64_tr_b16 v[42:43], v2 offset:51200
  v_mfma_f32_16x16x32_bf16 v[216:219], v[48:51], a[32:35], v[216:219]
  v_mfma_f32_16x16x32_bf16 v[220:223], v[52:55], a[24:27], v[220:223]
  ds_read_b64_tr_b16 v[44:45], v3 offset:49152
  v_mfma_f32_16x16x32_bf16 v[224:227], v[52:55], a[28:31], v[224:227]
  ds_read_b64_tr_b16 v[46:47], v3 offset:51200
  v_mfma_f32_16x16x32_bf16 v[228:231], v[52:55], a[32:35], v[228:231]
  s_waitcnt lgkmcnt(4)
  s_add_u32 m0, s33, 10240
  v_mfma_f32_16x16x32_bf16 v[232:235], v[56:59], a[24:27], v[232:235]
  ds_read_b64_tr_b16 v[48:49], v4 offset:49152
  s_mov_b32 s35, 16384
  v_mfma_f32_16x16x32_bf16 v[236:239], v[56:59], a[28:31], v[236:239]
  ds_read_b64_tr_b16 v[50:51], v4 offset:51200
  buffer_load_dwordx4 v24, s[12:15], s35 offen nt lds
  v_mfma_f32_16x16x32_bf16 v[240:243], v[56:59], a[32:35], v[240:243]
  buffer_load_dwordx4 v25, s[12:15], s35 offen offset:1024 nt lds
  v_mfma_f32_16x16x32_bf16 v[244:247], v[60:63], a[24:27], v[244:247]
  ds_read_b64_tr_b16 v[52:53], v5 offset:49152
  v_mfma_f32_16x16x32_bf16 v[248:251], v[60:63], a[28:31], v[248:251]
  ds_read_b64_tr_b16 v[54:55], v5 offset:51200
  v_mfma_f32_16x16x32_bf16 v[252:255], v[60:63], a[32:35], v[252:255]
  s_waitcnt lgkmcnt(4)
  s_waitcnt vmcnt(14)
  v_mfma_f32_16x16x32_bf16 v[64:67], v[40:43], a[36:39], v[64:67]
  ds_read_b64_tr_b16 v[56:57], v6 offset:49152
  s_barrier
  v_mfma_f32_16x16x32_bf16 v[68:71], v[40:43], a[40:43], v[68:71]
  ds_read_b64_tr_b16 v[58:59], v6 offset:51200
  v_mfma_f32_16x16x32_bf16 v[72:75], v[40:43], a[44:47], v[72:75]
  s_add_u32 m0, s33, 0
  v_mfma_f32_16x16x32_bf16 v[76:79], v[44:47], a[36:39], v[76:79]
  ds_read_b64_tr_b16 v[60:61], v7 offset:49152
  s_add_u32 s35, s53, 0
  v_mfma_f32_16x16x32_bf16 v[80:83], v[44:47], a[40:43], v[80:83]
  ds_read_b64_tr_b16 v[62:63], v7 offset:51200
  buffer_load_dwordx4 v22, s[4:7], s35 offen lds
  v_mfma_f32_16x16x32_bf16 v[84:87], v[44:47], a[44:47], v[84:87]
  s_waitcnt lgkmcnt(4)
  buffer_load_dwordx4 v23, s[4:7], s35 offen offset:1024 lds
  v_mfma_f32_16x16x32_bf16 v[88:91], v[48:51], a[36:39], v[88:91]
  ds_read_b64_tr_b16 v[40:41], v8 offset:49152
  v_mfma_f32_16x16x32_bf16 v[92:95], v[48:51], a[40:43], v[92:95]
  ds_read_b64_tr_b16 v[42:43], v8 offset:51200
  v_mfma_f32_16x16x32_bf16 v[96:99], v[48:51], a[44:47], v[96:99]
  v_mfma_f32_16x16x32_bf16 v[100:103], v[52:55], a[36:39], v[100:103]
  ds_read_b64_tr_b16 v[44:45], v9 offset:49152
  v_mfma_f32_16x16x32_bf16 v[104:107], v[52:55], a[40:43], v[104:107]
  ds_read_b64_tr_b16 v[46:47], v9 offset:51200
  v_mfma_f32_16x16x32_bf16 v[108:111], v[52:55], a[44:47], v[108:111]
  s_waitcnt lgkmcnt(4)
  s_add_u32 m0, s33, 2048
  v_mfma_f32_16x16x32_bf16 v[112:115], v[56:59], a[36:39], v[112:115]
  ds_read_b64_tr_b16 v[48:49], v2 offset:49408
  s_add_u32 s35, s53, 14336
  v_mfma_f32_16x16x32_bf16 v[116:119], v[56:59], a[40:43], v[116:119]
  ds_read_b64_tr_b16 v[50:51], v2 offset:51456
  buffer_load_dwordx4 v22, s[4:7], s35 offen lds
  v_mfma_f32_16x16x32_bf16 v[120:123], v[56:59], a[44:47], v[120:123]
  buffer_load_dwordx4 v23, s[4:7], s35 offen offset:1024 lds
  v_mfma_f32_16x16x32_bf16 v[124:127], v[60:63], a[36:39], v[124:127]
  ds_read_b64_tr_b16 v[52:53], v3 offset:49408
  v_mfma_f32_16x16x32_bf16 v[128:131], v[60:63], a[40:43], v[128:131]
  ds_read_b64_tr_b16 v[54:55], v3 offset:51456
  v_mfma_f32_16x16x32_bf16 v[132:135], v[60:63], a[44:47], v[132:135]
  s_waitcnt lgkmcnt(4)
  v_mfma_f32_16x16x32_bf16 v[136:139], v[40:43], a[36:39], v[136:139]
  ds_read_b64_tr_b16 v[56:57], v4 offset:49408
  v_mfma_f32_16x16x32_bf16 v[140:143], v[40:43], a[40:43], v[140:143]
  ds_read_b64_tr_b16 v[58:59], v4 offset:51456
  s_add_u32 m0, s33, 4096
  v_mfma_f32_16x16x32_bf16 v[144:147], v[40:43], a[44:47], v[144:147]
  s_add_u32 s35, s53, 28672
  buffer_load_dwordx4 v22, s[4:7], s35 offen lds
  v_mfma_f32_16x16x32_bf16 v[148:151], v[44:47], a[36:39], v[148:151]
  ds_read_b64_tr_b16 v[60:61], v5 offset:49408
  buffer_load_dwordx4 v23, s[4:7], s35 offen offset:1024 lds
  v_mfma_f32_16x16x32_bf16 v[152:155], v[44:47], a[40:43], v[152:155]
  ds_read_b64_tr_b16 v[62:63], v5 offset:51456
  v_mfma_f32_16x16x32_bf16 v[156:159], v[44:47], a[44:47], v[156:159]
  s_waitcnt lgkmcnt(4)
  v_mfma_f32_16x16x32_bf16 v[160:163], v[48:51], a[36:39], v[160:163]
  ds_read_b64_tr_b16 v[40:41], v6 offset:49408
  v_mfma_f32_16x16x32_bf16 v[164:167], v[48:51], a[40:43], v[164:167]
  ds_read_b64_tr_b16 v[42:43], v6 offset:51456
  v_mfma_f32_16x16x32_bf16 v[168:171], v[48:51], a[44:47], v[168:171]
  s_add_u32 m0, s27, 0
  s_nop 0
  v_mfma_f32_16x16x32_bf16 v[172:175], v[52:55], a[36:39], v[172:175]
  ds_read_b64_tr_b16 v[44:45], v7 offset:49408
  buffer_load_dwordx4 v18, s[8:11], s43 offen offset:0 lds
  v_mfma_f32_16x16x32_bf16 v[176:179], v[52:55], a[40:43], v[176:179]
  ds_read_b64_tr_b16 v[46:47], v7 offset:51456
  v_mfma_f32_16x16x32_bf16 v[180:183], v[52:55], a[44:47], v[180:183]
  s_waitcnt lgkmcnt(4)
  v_mfma_f32_16x16x32_bf16 v[184:187], v[56:59], a[36:39], v[184:187]
  ds_read_b64_tr_b16 v[48:49], v8 offset:49408
  buffer_load_dwordx4 v19, s[8:11], s43 offen offset:1024 lds
  v_mfma_f32_16x16x32_bf16 v[188:191], v[56:59], a[40:43], v[188:191]
  ds_read_b64_tr_b16 v[50:51], v8 offset:51456
  v_mfma_f32_16x16x32_bf16 v[192:195], v[56:59], a[44:47], v[192:195]
  v_mfma_f32_16x16x32_bf16 v[196:199], v[60:63], a[36:39], v[196:199]
  ds_read_b64_tr_b16 v[52:53], v9 offset:49408
  v_mfma_f32_16x16x32_bf16 v[200:203], v[60:63], a[40:43], v[200:203]
  ds_read_b64_tr_b16 v[54:55], v9 offset:51456
  buffer_load_dwordx4 v20, s[8:11], s43 offen offset:2048 lds
  v_mfma_f32_16x16x32_bf16 v[204:207], v[60:63], a[44:47], v[204:207]
  s_waitcnt lgkmcnt(4)
  v_mfma_f32_16x16x32_bf16 v[208:211], v[40:43], a[36:39], v[208:211]
  ds_read_b64_tr_b16 v[56:57], v10 offset:0
  v_mfma_f32_16x16x32_bf16 v[212:215], v[40:43], a[40:43], v[212:215]
  ds_read_b64_tr_b16 v[58:59], v10 offset:2048
  s_waitcnt vmcnt(13)
  v_mfma_f32_16x16x32_bf16 v[216:219], v[40:43], a[44:47], v[216:219]
  ds_read_b128 a[168:171], v26 offset:6144
  v_mfma_f32_16x16x32_bf16 v[220:223], v[44:47], a[36:39], v[220:223]
  ds_read_b64_tr_b16 v[60:61], v11 offset:0
  v_mfma_f32_16x16x32_bf16 v[224:227], v[44:47], a[40:43], v[224:227]
  ds_read_b64_tr_b16 v[62:63], v11 offset:2048
  ds_read_b128 a[180:183], v27 offset:6144
  v_mfma_f32_16x16x32_bf16 v[228:231], v[44:47], a[44:47], v[228:231]
  s_waitcnt lgkmcnt(6)
  buffer_load_dwordx4 v21, s[8:11], s43 offen offset:3072 lds
  v_mfma_f32_16x16x32_bf16 v[232:235], v[48:51], a[36:39], v[232:235]
  ds_read_b64_tr_b16 v[40:41], v12 offset:0
  s_add_u32 m0, s27, 16384
  v_mfma_f32_16x16x32_bf16 v[236:239], v[48:51], a[40:43], v[236:239]
  ds_read_b64_tr_b16 v[42:43], v12 offset:2048
  s_nop 0
  v_mfma_f32_16x16x32_bf16 v[240:243], v[48:51], a[44:47], v[240:243]
  buffer_load_dwordx4 v18, s[8:11], s44 offen offset:0 lds
  v_mfma_f32_16x16x32_bf16 v[244:247], v[52:55], a[36:39], v[244:247]
  ds_read_b64_tr_b16 v[44:45], v13 offset:0
  v_mfma_f32_16x16x32_bf16 v[248:251], v[52:55], a[40:43], v[248:251]
  ds_read_b64_tr_b16 v[46:47], v13 offset:2048
  buffer_load_dwordx4 v19, s[8:11], s44 offen offset:1024 lds
  v_mfma_f32_16x16x32_bf16 v[252:255], v[52:55], a[44:47], v[252:255]
  s_waitcnt lgkmcnt(5)
  v_mfma_f32_16x16x32_bf16 v[64:67], v[56:59], a[48:51], v[64:67]
  ds_read_b64_tr_b16 v[48:49], v14 offset:0
  s_barrier
  v_mfma_f32_16x16x32_bf16 v[68:71], v[56:59], a[52:55], v[68:71]
  ds_read_b64_tr_b16 v[50:51], v14 offset:2048
  s_waitcnt vmcnt(14)
  v_mfma_f32_16x16x32_bf16 v[72:75], v[56:59], a[56:59], v[72:75]
  ds_read_b128 a[172:175], v26 offset:8192
  ds_read_b128 a[184:187], v27 offset:8192
  v_mfma_f32_16x16x32_bf16 v[76:79], v[60:63], a[48:51], v[76:79]
  ds_read_b64_tr_b16 v[52:53], v15 offset:0
  buffer_load_dwordx4 v20, s[8:11], s44 offen offset:2048 lds
  v_mfma_f32_16x16x32_bf16 v[80:83], v[60:63], a[52:55], v[80:83]
  ds_read_b64_tr_b16 v[54:55], v15 offset:2048
  v_mfma_f32_16x16x32_bf16 v[84:87], v[60:63], a[56:59], v[84:87]
  s_waitcnt lgkmcnt(6)
  v_mfma_f32_16x16x32_bf16 v[88:91], v[40:43], a[48:51], v[88:91]
  ds_read_b64_tr_b16 v[56:57], v16 offset:0
  buffer_load_dwordx4 v21, s[8:11], s44 offen offset:3072 lds
  v_mfma_f32_16x16x32_bf16 v[92:95], v[40:43], a[52:55], v[92:95]
  ds_read_b64_tr_b16 v[58:59], v16 offset:2048
  v_mfma_f32_16x16x32_bf16 v[96:99], v[40:43], a[56:59], v[96:99]
  v_mfma_f32_16x16x32_bf16 v[100:103], v[44:47], a[48:51], v[100:103]
  ds_read_b64_tr_b16 v[60:61], v17 offset:0
  s_waitcnt vmcnt(14)
  v_mfma_f32_16x16x32_bf16 v[104:107], v[44:47], a[52:55], v[104:107]
  ds_read_b64_tr_b16 v[62:63], v17 offset:2048
  v_mfma_f32_16x16x32_bf16 v[108:111], v[44:47], a[56:59], v[108:111]
  s_waitcnt lgkmcnt(4)
  ds_read_b128 a[176:179], v26 offset:10240
  v_mfma_f32_16x16x32_bf16 v[112:115], v[48:51], a[48:51], v[112:115]
  ds_read_b64_tr_b16 v[40:41], v10 offset:256
  ds_read_b128 a[188:191], v27 offset:10240
  s_waitcnt vmcnt(12)
  ds_read_b128 a[72:75], v26 offset:0
  ds_read_b128 a[84:87], v27 offset:0
  s_waitcnt vmcnt(10)
  ds_read_b128 a[76:79], v26 offset:2048
  ds_read_b128 a[88:91], v27 offset:2048
  v_mfma_f32_16x16x32_bf16 v[116:119], v[48:51], a[52:55], v[116:119]
  ds_read_b64_tr_b16 v[42:43], v10 offset:2304
  s_waitcnt vmcnt(8)
  ds_read_b128 a[80:83], v26 offset:4096
  ds_read_b128 a[92:95], v27 offset:4096
  v_mfma_f32_16x16x32_bf16 v[120:123], v[48:51], a[56:59], v[120:123]
  s_add_u32 m0, s33, 6144
  v_mfma_f32_16x16x32_bf16 v[124:127], v[52:55], a[48:51], v[124:127]
  ds_read_b64_tr_b16 v[44:45], v11 offset:256
  s_mov_b32 s35, 128
  v_mfma_f32_16x16x32_bf16 v[128:131], v[52:55], a[52:55], v[128:131]
  s_waitcnt lgkmcnt(14)
  ds_read_b64_tr_b16 v[46:47], v11 offset:2304
  buffer_load_dwordx4 v24, s[12:15], s35 offen nt lds
  buffer_load_dwordx4 v25, s[12:15], s35 offen offset:1024 nt lds
  v_mfma_f32_16x16x32_bf16 v[132:135], v[52:55], a[56:59], v[132:135]
  s_waitcnt lgkmcnt(12)
  v_mfma_f32_16x16x32_bf16 v[136:139], v[56:59], a[48:51], v[136:139]
  ds_read_b64_tr_b16 v[48:49], v12 offset:256
  v_mfma_f32_16x16x32_bf16 v[140:143], v[56:59], a[52:55], v[140:143]
  ds_read_b64_tr_b16 v[50:51], v12 offset:2304
  v_mfma_f32_16x16x32_bf16 v[144:147], v[56:59], a[56:59], v[144:147]
  s_add_u32 m0, s33, 8192
  v_mfma_f32_16x16x32_bf16 v[148:151], v[60:63], a[48:51], v[148:151]
  ds_read_b64_tr_b16 v[52:53], v13 offset:256
  s_mov_b32 s35, 8320
  v_mfma_f32_16x16x32_bf16 v[152:155], v[60:63], a[52:55], v[152:155]
  s_waitcnt lgkmcnt(14)
  ds_read_b64_tr_b16 v[54:55], v13 offset:2304
  buffer_load_dwordx4 v24, s[12:15], s35 offen nt lds
  v_mfma_f32_16x16x32_bf16 v[156:159], v[60:63], a[56:59], v[156:159]
  s_waitcnt lgkmcnt(4)
  buffer_load_dwordx4 v25, s[12:15], s35 offen offset:1024 nt lds
  v_mfma_f32_16x16x32_bf16 v[160:163], v[40:43], a[48:51], v[160:163]
  ds_read_b64_tr_b16 v[56:57], v14 offset:256
  v_mfma_f32_16x16x32_bf16 v[164:167], v[40:43], a[52:55], v[164:167]
  ds_read_b64_tr_b16 v[58:59], v14 offset:2304
  v_mfma_f32_16x16x32_bf16 v[168:171], v[40:43], a[56:59], v[168:171]
  v_mfma_f32_16x16x32_bf16 v[172:175], v[44:47], a[48:51], v[172:175]
  ds_read_b64_tr_b16 v[60:61], v15 offset:256
  v_mfma_f32_16x16x32_bf16 v[176:179], v[44:47], a[52:55], v[176:179]
  ds_read_b64_tr_b16 v[62:63], v15 offset:2304
  v_mfma_f32_16x16x32_bf16 v[180:183], v[44:47], a[56:59], v[180:183]
  s_waitcnt lgkmcnt(4)
  v_mfma_f32_16x16x32_bf16 v[184:187], v[48:51], a[48:51], v[184:187]
  ds_read_b64_tr_b16 v[40:41], v16 offset:256
  v_mfma_f32_16x16x32_bf16 v[188:191], v[48:51], a[52:55], v[188:191]
  ds_read_b64_tr_b16 v[42:43], v16 offset:2304
  s_add_u32 m0, s33, 10240
  v_mfma_f32_16x16x32_bf16 v[192:195], v[48:51], a[56:59], v[192:195]
  s_mov_b32 s35, 16512
  buffer_load_dwordx4 v24, s[12:15], s35 offen nt lds
  v_mfma_f32_16x16x32_bf16 v[196:199], v[52:55], a[48:51], v[196:199]
  ds_read_b64_tr_b16 v[44:45], v17 offset:256
  buffer_load_dwordx4 v25, s[12:15], s35 offen offset:1024 nt lds
  v_mfma_f32_16x16x32_bf16 v[200:203], v[52:55], a[52:55], v[200:203]
  ds_read_b64_tr_b16 v[46:47], v17 offset:2304
  v_mfma_f32_16x16x32_bf16 v[204:207], v[52:55], a[56:59], v[204:207]
  s_waitcnt lgkmcnt(4)
  v_mfma_f32_16x16x32_bf16 v[208:211], v[56:59], a[48:51], v[208:211]
  ds_read_b64_tr_b16 v[48:49], v10 offset:16384
  v_mfma_f32_16x16x32_bf16 v[212:215], v[56:59], a[52:55], v[212:215]
  ds_read_b64_tr_b16 v[50:51], v10 offset:18432
  v_mfma_f32_16x16x32_bf16 v[216:219], v[56:59], a[56:59], v[216:219]
  v_mfma_f32_16x16x32_bf16 v[220:223], v[60:63], a[48:51], v[220:223]
  ds_read_b64_tr_b16 v[52:53], v11 offset:16384
  v_mfma_f32_16x16x32_bf16 v[224:227], v[60:63], a[52:55], v[224:227]
  ds_read_b64_tr_b16 v[54:55], v11 offset:18432
  v_mfma_f32_16x16x32_bf16 v[228:231], v[60:63], a[56:59], v[228:231]
  s_waitcnt lgkmcnt(4)
  s_add_u32 m0, s33, 0
  v_mfma_f32_16x16x32_bf16 v[232:235], v[40:43], a[48:51], v[232:235]
  ds_read_b64_tr_b16 v[56:57], v12 offset:16384
  s_add_u32 s35, s54, 0
  v_mfma_f32_16x16x32_bf16 v[236:239], v[40:43], a[52:55], v[236:239]
  ds_read_b64_tr_b16 v[58:59], v12 offset:18432
  buffer_load_dwordx4 v22, s[4:7], s35 offen lds
  v_mfma_f32_16x16x32_bf16 v[240:243], v[40:43], a[56:59], v[240:243]
  buffer_load_dwordx4 v23, s[4:7], s35 offen offset:1024 lds
  v_mfma_f32_16x16x32_bf16 v[244:247], v[44:47], a[48:51], v[244:247]
  ds_read_b64_tr_b16 v[60:61], v13 offset:16384
  v_mfma_f32_16x16x32_bf16 v[248:251], v[44:47], a[52:55], v[248:251]
  ds_read_b64_tr_b16 v[62:63], v13 offset:18432
  v_mfma_f32_16x16x32_bf16 v[252:255], v[44:47], a[56:59], v[252:255]
  s_waitcnt lgkmcnt(4)
  v_mfma_f32_16x16x32_bf16 v[64:67], v[48:51], a[60:63], v[64:67]
  ds_read_b64_tr_b16 v[40:41], v14 offset:16384
  s_barrier
  v_mfma_f32_16x16x32_bf16 v[68:71], v[48:51], a[64:67], v[68:71]
  ds_read_b64_tr_b16 v[42:43], v14 offset:18432
  v_mfma_f32_16x16x32_bf16 v[72:75], v[48:51], a[68:71], v[72:75]
  s_add_u32 m0, s33, 2048
  s_add_u32 s35, s54, 14336
  v_mfma_f32_16x16x32_bf16 v[76:79], v[52:55], a[60:63], v[76:79]
  ds_read_b64_tr_b16 v[44:45], v15 offset:16384
  buffer_load_dwordx4 v22, s[4:7], s35 offen lds
  v_mfma_f32_16x16x32_bf16 v[80:83], v[52:55], a[64:67], v[80:83]
  ds_read_b64_tr_b16 v[46:47], v15 offset:18432
  buffer_load_dwordx4 v23, s[4:7], s35 offen offset:1024 lds
  v_mfma_f32_16x16x32_bf16 v[84:87], v[52:55], a[68:71], v[84:87]
  s_waitcnt lgkmcnt(4)
  v_mfma_f32_16x16x32_bf16 v[88:91], v[56:59], a[60:63], v[88:91]
  ds_read_b64_tr_b16 v[48:49], v16 offset:16384
  v_mfma_f32_16x16x32_bf16 v[92:95], v[56:59], a[64:67], v[92:95]
  ds_read_b64_tr_b16 v[50:51], v16 offset:18432
  v_mfma_f32_16x16x32_bf16 v[96:99], v[56:59], a[68:71], v[96:99]
  s_add_u32 m0, s33, 4096
  v_mfma_f32_16x16x32_bf16 v[100:103], v[60:63], a[60:63], v[100:103]
  ds_read_b64_tr_b16 v[52:53], v17 offset:16384
  s_add_u32 s35, s54, 28672
  v_mfma_f32_16x16x32_bf16 v[104:107], v[60:63], a[64:67], v[104:107]
  ds_read_b64_tr_b16 v[54:55], v17 offset:18432
  buffer_load_dwordx4 v22, s[4:7], s35 offen lds
  v_mfma_f32_16x16x32_bf16 v[108:111], v[60:63], a[68:71], v[108:111]
  s_waitcnt lgkmcnt(4)
  buffer_load_dwordx4 v23, s[4:7], s35 offen offset:1024 lds
  v_mfma_f32_16x16x32_bf16 v[112:115], v[40:43], a[60:63], v[112:115]
  ds_read_b64_tr_b16 v[56:57], v10 offset:16640
  v_mfma_f32_16x16x32_bf16 v[116:119], v[40:43], a[64:67], v[116:119]
  ds_read_b64_tr_b16 v[58:59], v10 offset:18688
  v_mfma_f32_16x16x32_bf16 v[120:123], v[40:43], a[68:71], v[120:123]
  v_mfma_f32_16x16x32_bf16 v[124:127], v[44:47], a[60:63], v[124:127]
  ds_read_b64_tr_b16 v[60:61], v11 offset:16640
  v_mfma_f32_16x16x32_bf16 v[128:131], v[44:47], a[64:67], v[128:131]
  ds_read_b64_tr_b16 v[62:63], v11 offset:18688
  s_add_u32 m0, s27, 32768
  v_mfma_f32_16x16x32_bf16 v[132:135], v[44:47], a[68:71], v[132:135]
  s_waitcnt lgkmcnt(4)
  s_nop 0
  v_mfma_f32_16x16x32_bf16 v[136:139], v[48:51], a[60:63], v[136:139]
  ds_read_b64_tr_b16 v[40:41], v12 offset:16640
  buffer_load_dwordx4 v18, s[8:11], s45 offen offset:0 lds
  v_mfma_f32_16x16x32_bf16 v[140:143], v[48:51], a[64:67], v[140:143]
  ds_read_b64_tr_b16 v[42:43], v12 offset:18688
  v_mfma_f32_16x16x32_bf16 v[144:147], v[48:51], a[68:71], v[144:147]
  buffer_load_dwordx4 v19, s[8:11], s45 offen offset:1024 lds
  v_mfma_f32_16x16x32_bf16 v[148:151], v[52:55], a[60:63], v[148:151]
  ds_read_b64_tr_b16 v[44:45], v13 offset:16640
  v_mfma_f32_16x16x32_bf16 v[152:155], v[52:55], a[64:67], v[152:155]
  ds_read_b64_tr_b16 v[46:47], v13 offset:18688
  v_mfma_f32_16x16x32_bf16 v[156:159], v[52:55], a[68:71], v[156:159]
  s_waitcnt lgkmcnt(4)
  v_mfma_f32_16x16x32_bf16 v[160:163], v[56:59], a[60:63], v[160:163]
  ds_read_b64_tr_b16 v[48:49], v14 offset:16640
  buffer_load_dwordx4 v20, s[8:11], s45 offen offset:2048 lds
  v_mfma_f32_16x16x32_bf16 v[164:167], v[56:59], a[64:67], v[164:167]
  ds_read_b64_tr_b16 v[50:51], v14 offset:18688
  v_mfma_f32_16x16x32_bf16 v[168:171], v[56:59], a[68:71], v[168:171]
  v_mfma_f32_16x16x32_bf16 v[172:175], v[60:63], a[60:63], v[172:175]
  ds_read_b64_tr_b16 v[52:53], v15 offset:16640
  s_waitcnt vmcnt(13)
  v_mfma_f32_16x16x32_bf16 v[176:179], v[60:63], a[64:67], v[176:179]
  ds_read_b64_tr_b16 v[54:55], v15 offset:18688
  v_mfma_f32_16x16x32_bf16 v[180:183], v[60:63], a[68:71], v[180:183]
  s_waitcnt lgkmcnt(4)
  ds_read_b128 a[192:195], v26 offset:6144
  v_mfma_f32_16x16x32_bf16 v[184:187], v[40:43], a[60:63], v[184:187]
  ds_read_b64_tr_b16 v[56:57], v16 offset:16640
  ds_read_b128 a[204:207], v27 offset:6144
  v_mfma_f32_16x16x32_bf16 v[188:191], v[40:43], a[64:67], v[188:191]
  ds_read_b64_tr_b16 v[58:59], v16 offset:18688
  buffer_load_dwordx4 v21, s[8:11], s45 offen offset:3072 lds
  v_mfma_f32_16x16x32_bf16 v[192:195], v[40:43], a[68:71], v[192:195]
  s_add_u32 m0, s27, 49152
  s_nop 0
  v_mfma_f32_16x16x32_bf16 v[196:199], v[44:47], a[60:63], v[196:199]
  ds_read_b64_tr_b16 v[60:61], v17 offset:16640
  buffer_load_dwordx4 v18, s[8:11], s46 offen offset:0 lds
  v_mfma_f32_16x16x32_bf16 v[200:203], v[44:47], a[64:67], v[200:203]
  ds_read_b64_tr_b16 v[62:63], v17 offset:18688
  v_mfma_f32_16x16x32_bf16 v[204:207], v[44:47], a[68:71], v[204:207]
  s_waitcnt lgkmcnt(6)
  v_mfma_f32_16x16x32_bf16 v[208:211], v[48:51], a[60:63], v[208:211]
  ds_read_b64_tr_b16 v[40:41], v10 offset:32768
  buffer_load_dwordx4 v19, s[8:11], s46 offen offset:1024 lds
  v_mfma_f32_16x16x32_bf16 v[212:215], v[48:51], a[64:67], v[212:215]
  ds_read_b64_tr_b16 v[42:43], v10 offset:34816
  s_waitcnt vmcnt(14)
  v_mfma_f32_16x16x32_bf16 v[216:219], v[48:51], a[68:71], v[216:219]
  ds_read_b128 a[196:199], v26 offset:8192
  v_mfma_f32_16x16x32_bf16 v[220:223], v[52:55], a[60:63], v[220:223]
  ds_read_b64_tr_b16 v[44:45], v11 offset:32768
  v_mfma_f32_16x16x32_bf16 v[224:227], v[52:55], a[64:67], v[224:227]
  ds_read_b64_tr_b16 v[46:47], v11 offset:34816
  ds_read_b128 a[208:211], v27 offset:8192
  v_mfma_f32_16x16x32_bf16 v[228:231], v[52:55], a[68:71], v[228:231]
  s_waitcnt lgkmcnt(6)
  buffer_load_dwordx4 v20, s[8:11], s46 offen offset:2048 lds
  v_mfma_f32_16x16x32_bf16 v[232:235], v[56:59], a[60:63], v[232:235]
  ds_read_b64_tr_b16 v[48:49], v12 offset:32768
  v_mfma_f32_16x16x32_bf16 v[236:239], v[56:59], a[64:67], v[236:239]
  ds_read_b64_tr_b16 v[50:51], v12 offset:34816
  v_mfma_f32_16x16x32_bf16 v[240:243], v[56:59], a[68:71], v[240:243]
  buffer_load_dwordx4 v21, s[8:11], s46 offen offset:3072 lds
  v_mfma_f32_16x16x32_bf16 v[244:247], v[60:63], a[60:63], v[244:247]
  ds_read_b64_tr_b16 v[52:53], v13 offset:32768
  v_mfma_f32_16x16x32_bf16 v[248:251], v[60:63], a[64:67], v[248:251]
  ds_read_b64_tr_b16 v[54:55], v13 offset:34816
  v_mfma_f32_16x16x32_bf16 v[252:255], v[60:63], a[68:71], v[252:255]
  s_waitcnt lgkmcnt(5)
  v_mfma_f32_16x16x32_bf16 v[64:67], v[40:43], a[72:75], v[64:67]
  ds_read_b64_tr_b16 v[56:57], v14 offset:32768
  s_barrier
  v_mfma_f32_16x16x32_bf16 v[68:71], v[40:43], a[76:79], v[68:71]
  ds_read_b64_tr_b16 v[58:59], v14 offset:34816
  s_waitcnt vmcnt(14)
  v_mfma_f32_16x16x32_bf16 v[72:75], v[40:43], a[80:83], v[72:75]
  ds_read_b128 a[200:203], v26 offset:10240
  ds_read_b128 a[212:215], v27 offset:10240
  s_waitcnt vmcnt(12)
  ds_read_b128 a[96:99], v26 offset:0
  ds_read_b128 a[108:111], v27 offset:0
  s_waitcnt vmcnt(10)
  ds_read_b128 a[100:103], v26 offset:2048
  ds_read_b128 a[112:115], v27 offset:2048
  v_mfma_f32_16x16x32_bf16 v[76:79], v[44:47], a[72:75], v[76:79]
  ds_read_b64_tr_b16 v[60:61], v15 offset:32768
  s_waitcnt vmcnt(8)
  ds_read_b128 a[104:107], v26 offset:4096
  s_waitcnt lgkmcnt(14)
  ds_read_b128 a[116:119], v27 offset:4096
  v_mfma_f32_16x16x32_bf16 v[80:83], v[44:47], a[76:79], v[80:83]
  s_waitcnt lgkmcnt(14)
  ds_read_b64_tr_b16 v[62:63], v15 offset:34816
  v_mfma_f32_16x16x32_bf16 v[84:87], v[44:47], a[80:83], v[84:87]
  s_waitcnt lgkmcnt(12)
  s_add_u32 m0, s33, 6144
  v_mfma_f32_16x16x32_bf16 v[88:91], v[48:51], a[72:75], v[88:91]
  ds_read_b64_tr_b16 v[40:41], v16 offset:32768
  s_add_u32 s35, s55, 0
  buffer_load_dwordx4 v22, s[4:7], s35 offen lds
  buffer_load_dwordx4 v23, s[4:7], s35 offen offset:1024 lds
  v_mfma_f32_16x16x32_bf16 v[92:95], v[48:51], a[76:79], v[92:95]
  ds_read_b64_tr_b16 v[42:43], v16 offset:34816
  v_mfma_f32_16x16x32_bf16 v[96:99], v[48:51], a[80:83], v[96:99]
  s_add_u32 m0, s33, 8192
  v_mfma_f32_16x16x32_bf16 v[100:103], v[52:55], a[72:75], v[100:103]
  ds_read_b64_tr_b16 v[44:45], v17 offset:32768
  s_add_u32 s35, s55, 14336
  v_mfma_f32_16x16x32_bf16 v[104:107], v[52:55], a[76:79], v[104:107]
  s_waitcnt lgkmcnt(14)
  ds_read_b64_tr_b16 v[46:47], v17 offset:34816
  buffer_load_dwordx4 v22, s[4:7], s35 offen lds
  v_mfma_f32_16x16x32_bf16 v[108:111], v[52:55], a[80:83], v[108:111]
  s_waitcnt lgkmcnt(4)
  buffer_load_dwordx4 v23, s[4:7], s35 offen offset:1024 lds
  v_mfma_f32_16x16x32_bf16 v[112:115], v[56:59], a[72:75], v[112:115]
  ds_read_b64_tr_b16 v[48:49], v10 offset:33024
  v_mfma_f32_16x16x32_bf16 v[116:119], v[56:59], a[76:79], v[116:119]
  ds_read_b64_tr_b16 v[50:51], v10 offset:35072
  v_mfma_f32_16x16x32_bf16 v[120:123], v[56:59], a[80:83], v[120:123]
  v_mfma_f32_16x16x32_bf16 v[124:127], v[60:63], a[72:75], v[124:127]
  ds_read_b64_tr_b16 v[52:53], v11 offset:33024
  v_mfma_f32_16x16x32_bf16 v[128:131], v[60:63], a[76:79], v[128:131]
  ds_read_b64_tr_b16 v[54:55], v11 offset:35072
  v_mfma_f32_16x16x32_bf16 v[132:135], v[60:63], a[80:83], v[132:135]
  s_waitcnt lgkmcnt(4)
  s_add_u32 m0, s33, 10240
  v_mfma_f32_16x16x32_bf16 v[136:139], v[40:43], a[72:75], v[136:139]
  ds_read_b64_tr_b16 v[56:57], v12 offset:33024
  s_add_u32 s35, s55, 28672
  v_mfma_f32_16x16x32_bf16 v[140:143], v[40:43], a[76:79], v[140:143]
  ds_read_b64_tr_b16 v[58:59], v12 offset:35072
  buffer_load_dwordx4 v22, s[4:7], s35 offen lds
  v_mfma_f32_16x16x32_bf16 v[144:147], v[40:43], a[80:83], v[144:147]
  buffer_load_dwordx4 v23, s[4:7], s35 offen offset:1024 lds
  v_mfma_f32_16x16x32_bf16 v[148:151], v[44:47], a[72:75], v[148:151]
  ds_read_b64_tr_b16 v[60:61], v13 offset:33024
  v_mfma_f32_16x16x32_bf16 v[152:155], v[44:47], a[76:79], v[152:155]
  ds_read_b64_tr_b16 v[62:63], v13 offset:35072
  v_mfma_f32_16x16x32_bf16 v[156:159], v[44:47], a[80:83], v[156:159]
  s_waitcnt lgkmcnt(4)
  v_mfma_f32_16x16x32_bf16 v[160:163], v[48:51], a[72:75], v[160:163]
  ds_read_b64_tr_b16 v[40:41], v14 offset:33024
  s_add_u32 m0, s27, 65536
  v_mfma_f32_16x16x32_bf16 v[164:167], v[48:51], a[76:79], v[164:167]
  ds_read_b64_tr_b16 v[42:43], v14 offset:35072
  s_nop 0
  v_mfma_f32_16x16x32_bf16 v[168:171], v[48:51], a[80:83], v[168:171]
  buffer_load_dwordx4 v18, s[8:11], s47 offen offset:0 lds
  v_mfma_f32_16x16x32_bf16 v[172:175], v[52:55], a[72:75], v[172:175]
  ds_read_b64_tr_b16 v[44:45], v15 offset:33024
  v_mfma_f32_16x16x32_bf16 v[176:179], v[52:55], a[76:79], v[176:179]
  ds_read_b64_tr_b16 v[46:47], v15 offset:35072
  buffer_load_dwordx4 v19, s[8:11], s47 offen offset:1024 lds
  v_mfma_f32_16x16x32_bf16 v[180:183], v[52:55], a[80:83], v[180:183]
  s_waitcnt lgkmcnt(4)
  v_mfma_f32_16x16x32_bf16 v[184:187], v[56:59], a[72:75], v[184:187]
  ds_read_b64_tr_b16 v[48:49], v16 offset:33024
  v_mfma_f32_16x16x32_bf16 v[188:191], v[56:59], a[76:79], v[188:191]
  ds_read_b64_tr_b16 v[50:51], v16 offset:35072
  v_mfma_f32_16x16x32_bf16 v[192:195], v[56:59], a[80:83], v[192:195]
  buffer_load_dwordx4 v20, s[8:11], s47 offen offset:2048 lds
  v_mfma_f32_16x16x32_bf16 v[196:199], v[60:63], a[72:75], v[196:199]
  ds_read_b64_tr_b16 v[52:53], v17 offset:33024
  v_mfma_f32_16x16x32_bf16 v[200:203], v[60:63], a[76:79], v[200:203]
  ds_read_b64_tr_b16 v[54:55], v17 offset:35072
  v_mfma_f32_16x16x32_bf16 v[204:207], v[60:63], a[80:83], v[204:207]
  s_waitcnt lgkmcnt(4)
  v_mfma_f32_16x16x32_bf16 v[208:211], v[40:43], a[72:75], v[208:211]
  ds_read_b64_tr_b16 v[56:57], v2 offset:0
  buffer_load_dwordx4 v21, s[8:11], s47 offen offset:3072 lds
  v_mfma_f32_16x16x32_bf16 v[212:215], v[40:43], a[76:79], v[212:215]
  ds_read_b64_tr_b16 v[58:59], v2 offset:2048
  v_mfma_f32_16x16x32_bf16 v[216:219], v[40:43], a[80:83], v[216:219]
  v_mfma_f32_16x16x32_bf16 v[220:223], v[44:47], a[72:75], v[220:223]
  ds_read_b64_tr_b16 v[60:61], v3 offset:0
  v_mfma_f32_16x16x32_bf16 v[224:227], v[44:47], a[76:79], v[224:227]
  ds_read_b64_tr_b16 v[62:63], v3 offset:2048
  s_waitcnt vmcnt(8)
  v_mfma_f32_16x16x32_bf16 v[228:231], v[44:47], a[80:83], v[228:231]
  s_waitcnt lgkmcnt(4)
  ds_read_b128 a[120:123], v26 offset:6144
  v_mfma_f32_16x16x32_bf16 v[232:235], v[48:51], a[72:75], v[232:235]
  ds_read_b64_tr_b16 v[40:41], v4 offset:0
  v_mfma_f32_16x16x32_bf16 v[236:239], v[48:51], a[76:79], v[236:239]
  ds_read_b64_tr_b16 v[42:43], v4 offset:2048
  ds_read_b128 a[132:135], v27 offset:6144
  v_mfma_f32_16x16x32_bf16 v[240:243], v[48:51], a[80:83], v[240:243]
  s_add_u32 m0, s33, 0
  v_mfma_f32_16x16x32_bf16 v[244:247], v[52:55], a[72:75], v[244:247]
  ds_read_b64_tr_b16 v[44:45], v5 offset:0
  s_mov_b32 s35, 256
  v_mfma_f32_16x16x32_bf16 v[248:251], v[52:55], a[76:79], v[248:251]
  ds_read_b64_tr_b16 v[46:47], v5 offset:2048
  buffer_load_dwordx4 v24, s[12:15], s35 offen nt lds
  buffer_load_dwordx4 v25, s[12:15], s35 offen offset:1024 nt lds
  v_mfma_f32_16x16x32_bf16 v[252:255], v[52:55], a[80:83], v[252:255]
  s_waitcnt lgkmcnt(6)
  v_mfma_f32_16x16x32_bf16 v[64:67], v[56:59], a[84:87], v[64:67]
  ds_read_b64_tr_b16 v[48:49], v6 offset:0
  s_barrier
  v_mfma_f32_16x16x32_bf16 v[68:71], v[56:59], a[88:91], v[68:71]
  ds_read_b64_tr_b16 v[50:51], v6 offset:2048
  s_waitcnt vmcnt(8)
  v_mfma_f32_16x16x32_bf16 v[72:75], v[56:59], a[92:95], v[72:75]
  ds_read_b128 a[124:127], v26 offset:8192
  v_mfma_f32_16x16x32_bf16 v[76:79], v[60:63], a[84:87], v[76:79]
  ds_read_b64_tr_b16 v[52:53], v7 offset:0
  ds_read_b128 a[136:139], v27 offset:8192
  v_mfma_f32_16x16x32_bf16 v[80:83], v[60:63], a[88:91], v[80:83]
  ds_read_b64_tr_b16 v[54:55], v7 offset:2048
  v_mfma_f32_16x16x32_bf16 v[84:87], v[60:63], a[92:95], v[84:87]
  s_waitcnt lgkmcnt(6)
  s_add_u32 m0, s33, 2048
  v_mfma_f32_16x16x32_bf16 v[88:91], v[40:43], a[84:87], v[88:91]
  ds_read_b64_tr_b16 v[56:57], v8 offset:0
  s_mov_b32 s35, 8448
  v_mfma_f32_16x16x32_bf16 v[92:95], v[40:43], a[88:91], v[92:95]
  ds_read_b64_tr_b16 v[58:59], v8 offset:2048
  buffer_load_dwordx4 v24, s[12:15], s35 offen nt lds
  v_mfma_f32_16x16x32_bf16 v[96:99], v[40:43], a[92:95], v[96:99]
  buffer_load_dwordx4 v25, s[12:15], s35 offen offset:1024 nt lds
  s_waitcnt vmcnt(8)
  v_mfma_f32_16x16x32_bf16 v[100:103], v[44:47], a[84:87], v[100:103]
  ds_read_b64_tr_b16 v[60:61], v9 offset:0
  v_mfma_f32_16x16x32_bf16 v[104:107], v[44:47], a[88:91], v[104:107]
  ds_read_b64_tr_b16 v[62:63], v9 offset:2048
  v_mfma_f32_16x16x32_bf16 v[108:111], v[44:47], a[92:95], v[108:111]
  s_waitcnt lgkmcnt(4)
  ds_read_b128 a[128:131], v26 offset:10240
  ds_read_b128 a[140:143], v27 offset:10240
  v_mfma_f32_16x16x32_bf16 v[112:115], v[48:51], a[84:87], v[112:115]
  ds_read_b64_tr_b16 v[40:41], v2 offset:256
  v_mfma_f32_16x16x32_bf16 v[116:119], v[48:51], a[88:91], v[116:119]
  ds_read_b64_tr_b16 v[42:43], v2 offset:2304
  s_add_u32 m0, s33, 4096
  v_mfma_f32_16x16x32_bf16 v[120:123], v[48:51], a[92:95], v[120:123]
  s_mov_b32 s35, 16640
  buffer_load_dwordx4 v24, s[12:15], s35 offen nt lds
  v_mfma_f32_16x16x32_bf16 v[124:127], v[52:55], a[84:87], v[124:127]
  ds_read_b64_tr_b16 v[44:45], v3 offset:256
  buffer_load_dwordx4 v25, s[12:15], s35 offen offset:1024 nt lds
  v_mfma_f32_16x16x32_bf16 v[128:131], v[52:55], a[88:91], v[128:131]
  ds_read_b64_tr_b16 v[46:47], v3 offset:2304
  v_mfma_f32_16x16x32_bf16 v[132:135], v[52:55], a[92:95], v[132:135]
  s_waitcnt lgkmcnt(6)
  v_mfma_f32_16x16x32_bf16 v[136:139], v[56:59], a[84:87], v[136:139]
  ds_read_b64_tr_b16 v[48:49], v4 offset:256
  v_mfma_f32_16x16x32_bf16 v[140:143], v[56:59], a[88:91], v[140:143]
  ds_read_b64_tr_b16 v[50:51], v4 offset:2304
  v_mfma_f32_16x16x32_bf16 v[144:147], v[56:59], a[92:95], v[144:147]
  v_mfma_f32_16x16x32_bf16 v[148:151], v[60:63], a[84:87], v[148:151]
  ds_read_b64_tr_b16 v[52:53], v5 offset:256
  v_mfma_f32_16x16x32_bf16 v[152:155], v[60:63], a[88:91], v[152:155]
  ds_read_b64_tr_b16 v[54:55], v5 offset:2304
  s_add_u32 m0, s27, 81920
  v_mfma_f32_16x16x32_bf16 v[156:159], v[60:63], a[92:95], v[156:159]
  s_waitcnt lgkmcnt(4)
  s_nop 0
  v_mfma_f32_16x16x32_bf16 v[160:163], v[40:43], a[84:87], v[160:163]
  ds_read_b64_tr_b16 v[56:57], v6 offset:256
  buffer_load_dwordx4 v18, s[8:11], s48 offen offset:0 lds
  v_mfma_f32_16x16x32_bf16 v[164:167], v[40:43], a[88:91], v[164:167]
  ds_read_b64_tr_b16 v[58:59], v6 offset:2304
  v_mfma_f32_16x16x32_bf16 v[168:171], v[40:43], a[92:95], v[168:171]
  buffer_load_dwordx4 v19, s[8:11], s48 offen offset:1024 lds
  v_mfma_f32_16x16x32_bf16 v[172:175], v[44:47], a[84:87], v[172:175]
  ds_read_b64_tr_b16 v[60:61], v7 offset:256
  v_mfma_f32_16x16x32_bf16 v[176:179], v[44:47], a[88:91], v[176:179]
  ds_read_b64_tr_b16 v[62:63], v7 offset:2304
  v_mfma_f32_16x16x32_bf16 v[180:183], v[44:47], a[92:95], v[180:183]
  s_waitcnt lgkmcnt(4)
  v_mfma_f32_16x16x32_bf16 v[184:187], v[48:51], a[84:87], v[184:187]
  ds_read_b64_tr_b16 v[40:41], v8 offset:256
  buffer_load_dwordx4 v20, s[8:11], s48 offen offset:2048 lds
  v_mfma_f32_16x16x32_bf16 v[188:191], v[48:51], a[88:91], v[188:191]
  ds_read_b64_tr_b16 v[42:43], v8 offset:2304
  v_mfma_f32_16x16x32_bf16 v[192:195], v[48:51], a[92:95], v[192:195]
  v_mfma_f32_16x16x32_bf16 v[196:199], v[52:55], a[84:87], v[196:199]
  ds_read_b64_tr_b16 v[44:45], v9 offset:256
  v_mfma_f32_16x16x32_bf16 v[200:203], v[52:55], a[88:91], v[200:203]
  ds_read_b64_tr_b16 v[46:47], v9 offset:2304
  buffer_load_dwordx4 v21, s[8:11], s48 offen offset:3072 lds
  v_mfma_f32_16x16x32_bf16 v[204:207], v[52:55], a[92:95], v[204:207]
  s_waitcnt lgkmcnt(4)
  v_mfma_f32_16x16x32_bf16 v[208:211], v[56:59], a[84:87], v[208:211]
  ds_read_b64_tr_b16 v[48:49], v2 offset:16384
  v_mfma_f32_16x16x32_bf16 v[212:215], v[56:59], a[88:91], v[212:215]
  ds_read_b64_tr_b16 v[50:51], v2 offset:18432
  v_mfma_f32_16x16x32_bf16 v[216:219], v[56:59], a[92:95], v[216:219]
  s_add_u32 m0, s33, 6144
  v_mfma_f32_16x16x32_bf16 v[220:223], v[60:63], a[84:87], v[220:223]
  ds_read_b64_tr_b16 v[52:53], v3 offset:16384
  s_add_u32 s35, s56, 0
  v_mfma_f32_16x16x32_bf16 v[224:227], v[60:63], a[88:91], v[224:227]
  ds_read_b64_tr_b16 v[54:55], v3 offset:18432
  buffer_load_dwordx4 v22, s[4:7], s35 offen lds
  v_mfma_f32_16x16x32_bf16 v[228:231], v[60:63], a[92:95], v[228:231]
  s_waitcnt lgkmcnt(4)
  buffer_load_dwordx4 v23, s[4:7], s35 offen offset:1024 lds
  v_mfma_f32_16x16x32_bf16 v[232:235], v[40:43], a[84:87], v[232:235]
  ds_read_b64_tr_b16 v[56:57], v4 offset:16384
  v_mfma_f32_16x16x32_bf16 v[236:239], v[40:43], a[88:91], v[236:239]
  ds_read_b64_tr_b16 v[58:59], v4 offset:18432
  v_mfma_f32_16x16x32_bf16 v[240:243], v[40:43], a[92:95], v[240:243]
  v_mfma_f32_16x16x32_bf16 v[244:247], v[44:47], a[84:87], v[244:247]
  ds_read_b64_tr_b16 v[60:61], v5 offset:16384
  v_mfma_f32_16x16x32_bf16 v[248:251], v[44:47], a[88:91], v[248:251]
  ds_read_b64_tr_b16 v[62:63], v5 offset:18432
  v_mfma_f32_16x16x32_bf16 v[252:255], v[44:47], a[92:95], v[252:255]
  s_waitcnt lgkmcnt(4)
  s_add_u32 m0, s33, 8192
  v_mfma_f32_16x16x32_bf16 v[64:67], v[48:51], a[96:99], v[64:67]
  ds_read_b64_tr_b16 v[40:41], v6 offset:16384
  s_add_u32 s35, s56, 14336
  v_mfma_f32_16x16x32_bf16 v[68:71], v[48:51], a[100:103], v[68:71]
  ds_read_b64_tr_b16 v[42:43], v6 offset:18432
  buffer_load_dwordx4 v22, s[4:7], s35 offen lds
  v_mfma_f32_16x16x32_bf16 v[72:75], v[48:51], a[104:107], v[72:75]
  buffer_load_dwordx4 v23, s[4:7], s35 offen offset:1024 lds
  v_mfma_f32_16x16x32_bf16 v[76:79], v[52:55], a[96:99], v[76:79]
  ds_read_b64_tr_b16 v[44:45], v7 offset:16384
  s_barrier
  v_mfma_f32_16x16x32_bf16 v[80:83], v[52:55], a[100:103], v[80:83]
  ds_read_b64_tr_b16 v[46:47], v7 offset:18432
  v_mfma_f32_16x16x32_bf16 v[84:87], v[52:55], a[104:107], v[84:87]
  s_waitcnt lgkmcnt(4)
  v_mfma_f32_16x16x32_bf16 v[88:91], v[56:59], a[96:99], v[88:91]
  ds_read_b64_tr_b16 v[48:49], v8 offset:16384
  v_mfma_f32_16x16x32_bf16 v[92:95], v[56:59], a[100:103], v[92:95]
  ds_read_b64_tr_b16 v[50:51], v8 offset:18432
  s_add_u32 m0, s33, 10240
  v_mfma_f32_16x16x32_bf16 v[96:99], v[56:59], a[104:107], v[96:99]
  s_add_u32 s35, s56, 28672
  buffer_load_dwordx4 v22, s[4:7], s35 offen lds
  v_mfma_f32_16x16x32_bf16 v[100:103], v[60:63], a[96:99], v[100:103]
  ds_read_b64_tr_b16 v[52:53], v9 offset:16384
  buffer_load_dwordx4 v23, s[4:7], s35 offen offset:1024 lds
  v_mfma_f32_16x16x32_bf16 v[104:107], v[60:63], a[100:103], v[104:107]
  ds_read_b64_tr_b16 v[54:55], v9 offset:18432
  s_waitcnt vmcnt(14)
  v_mfma_f32_16x16x32_bf16 v[108:111], v[60:63], a[104:107], v[108:111]
  s_waitcnt lgkmcnt(4)
  ds_read_b128 a[216:219], v26 offset:0
  v_mfma_f32_16x16x32_bf16 v[112:115], v[40:43], a[96:99], v[112:115]
  ds_read_b64_tr_b16 v[56:57], v2 offset:16640
  ds_read_b128 a[228:231], v27 offset:0
  v_mfma_f32_16x16x32_bf16 v[116:119], v[40:43], a[100:103], v[116:119]
  ds_read_b64_tr_b16 v[58:59], v2 offset:18688
  v_mfma_f32_16x16x32_bf16 v[120:123], v[40:43], a[104:107], v[120:123]
  s_add_u32 m0, s27, 98304
  s_nop 0
  v_mfma_f32_16x16x32_bf16 v[124:127], v[44:47], a[96:99], v[124:127]
  ds_read_b64_tr_b16 v[60:61], v3 offset:16640
  buffer_load_dwordx4 v18, s[8:11], s49 offen offset:0 lds
  v_mfma_f32_16x16x32_bf16 v[128:131], v[44:47], a[100:103], v[128:131]
  ds_read_b64_tr_b16 v[62:63], v3 offset:18688
  v_mfma_f32_16x16x32_bf16 v[132:135], v[44:47], a[104:107], v[132:135]
  s_waitcnt lgkmcnt(6)
  v_mfma_f32_16x16x32_bf16 v[136:139], v[48:51], a[96:99], v[136:139]
  ds_read_b64_tr_b16 v[40:41], v4 offset:16640
  buffer_load_dwordx4 v19, s[8:11], s49 offen offset:1024 lds
  v_mfma_f32_16x16x32_bf16 v[140:143], v[48:51], a[100:103], v[140:143]
  ds_read_b64_tr_b16 v[42:43], v4 offset:18688
  s_waitcnt vmcnt(14)
  v_mfma_f32_16x16x32_bf16 v[144:147], v[48:51], a[104:107], v[144:147]
  ds_read_b128 a[220:223], v26 offset:2048
  v_mfma_f32_16x16x32_bf16 v[148:151], v[52:55], a[96:99], v[148:151]
  ds_read_b64_tr_b16 v[44:45], v5 offset:16640
  v_mfma_f32_16x16x32_bf16 v[152:155], v[52:55], a[100:103], v[152:155]
  ds_read_b64_tr_b16 v[46:47], v5 offset:18688
  ds_read_b128 a[232:235], v27 offset:2048
  v_mfma_f32_16x16x32_bf16 v[156:159], v[52:55], a[104:107], v[156:159]
  s_waitcnt lgkmcnt(6)
  buffer_load_dwordx4 v20, s[8:11], s49 offen offset:2048 lds
  v_mfma_f32_16x16x32_bf16 v[160:163], v[56:59], a[96:99], v[160:163]
  ds_read_b64_tr_b16 v[48:49], v6 offset:16640
  v_mfma_f32_16x16x32_bf16 v[164:167], v[56:59], a[100:103], v[164:167]
  ds_read_b64_tr_b16 v[50:51], v6 offset:18688
  v_mfma_f32_16x16x32_bf16 v[168:171], v[56:59], a[104:107], v[168:171]
  buffer_load_dwordx4 v21, s[8:11], s49 offen offset:3072 lds
  v_mfma_f32_16x16x32_bf16 v[172:175], v[60:63], a[96:99], v[172:175]
  ds_read_b64_tr_b16 v[52:53], v7 offset:16640
  v_mfma_f32_16x16x32_bf16 v[176:179], v[60:63], a[100:103], v[176:179]
  ds_read_b64_tr_b16 v[54:55], v7 offset:18688
  v_mfma_f32_16x16x32_bf16 v[180:183], v[60:63], a[104:107], v[180:183]
  s_waitcnt lgkmcnt(5)
  s_waitcnt vmcnt(14)
  v_mfma_f32_16x16x32_bf16 v[184:187], v[40:43], a[96:99], v[184:187]
  ds_read_b64_tr_b16 v[56:57], v8 offset:16640
  v_mfma_f32_16x16x32_bf16 v[188:191], v[40:43], a[100:103], v[188:191]
  ds_read_b64_tr_b16 v[58:59], v8 offset:18688
  v_mfma_f32_16x16x32_bf16 v[192:195], v[40:43], a[104:107], v[192:195]
  ds_read_b128 a[224:227], v26 offset:4096
  ds_read_b128 a[236:239], v27 offset:4096
  v_mfma_f32_16x16x32_bf16 v[196:199], v[44:47], a[96:99], v[196:199]
  ds_read_b64_tr_b16 v[60:61], v9 offset:16640
  s_waitcnt vmcnt(8)
  ds_read_b128 a[144:147], v26 offset:6144
  ds_read_b128 a[156:159], v27 offset:6144
  v_mfma_f32_16x16x32_bf16 v[200:203], v[44:47], a[100:103], v[200:203]
  ds_read_b64_tr_b16 v[62:63], v9 offset:18688
  v_mfma_f32_16x16x32_bf16 v[204:207], v[44:47], a[104:107], v[204:207]
  s_waitcnt lgkmcnt(8)
  s_add_u32 m0, s33, 0
  v_mfma_f32_16x16x32_bf16 v[208:211], v[48:51], a[96:99], v[208:211]
  ds_read_b64_tr_b16 v[40:41], v2 offset:32768
  s_mov_b32 s35, 384
  buffer_load_dwordx4 v24, s[12:15], s35 offen nt lds
  buffer_load_dwordx4 v25, s[12:15], s35 offen offset:1024 nt lds
  v_mfma_f32_16x16x32_bf16 v[212:215], v[48:51], a[100:103], v[212:215]
  ds_read_b64_tr_b16 v[42:43], v2 offset:34816
  v_mfma_f32_16x16x32_bf16 v[216:219], v[48:51], a[104:107], v[216:219]
  s_waitcnt vmcnt(8)
  ds_read_b128 a[148:151], v26 offset:8192
  v_mfma_f32_16x16x32_bf16 v[220:223], v[52:55], a[96:99], v[220:223]
  ds_read_b64_tr_b16 v[44:45], v3 offset:32768
  v_mfma_f32_16x16x32_bf16 v[224:227], v[52:55], a[100:103], v[224:227]
  ds_read_b64_tr_b16 v[46:47], v3 offset:34816
  v_mfma_f32_16x16x32_bf16 v[228:231], v[52:55], a[104:107], v[228:231]
  s_waitcnt lgkmcnt(5)
  ds_read_b128 a[160:163], v27 offset:8192
  v_mfma_f32_16x16x32_bf16 v[232:235], v[56:59], a[96:99], v[232:235]
  ds_read_b64_tr_b16 v[48:49], v4 offset:32768
  v_mfma_f32_16x16x32_bf16 v[236:239], v[56:59], a[100:103], v[236:239]
  ds_read_b64_tr_b16 v[50:51], v4 offset:34816
  s_add_u32 m0, s33, 2048
  v_mfma_f32_16x16x32_bf16 v[240:243], v[56:59], a[104:107], v[240:243]
  s_mov_b32 s35, 8576
  buffer_load_dwordx4 v24, s[12:15], s35 offen nt lds
  v_mfma_f32_16x16x32_bf16 v[244:247], v[60:63], a[96:99], v[244:247]
  ds_read_b64_tr_b16 v[52:53], v5 offset:32768
  buffer_load_dwordx4 v25, s[12:15], s35 offen offset:1024 nt lds
  v_mfma_f32_16x16x32_bf16 v[248:251], v[60:63], a[100:103], v[248:251]
  ds_read_b64_tr_b16 v[54:55], v5 offset:34816
  s_waitcnt vmcnt(8)
  v_mfma_f32_16x16x32_bf16 v[252:255], v[60:63], a[104:107], v[252:255]
  s_waitcnt lgkmcnt(5)
  ds_read_b128 a[152:155], v26 offset:10240
  v_mfma_f32_16x16x32_bf16 v[64:67], v[40:43], a[108:111], v[64:67]
  ds_read_b64_tr_b16 v[56:57], v6 offset:32768
  v_mfma_f32_16x16x32_bf16 v[68:71], v[40:43], a[112:115], v[68:71]
  ds_read_b64_tr_b16 v[58:59], v6 offset:34816
  ds_read_b128 a[164:167], v27 offset:10240
  v_mfma_f32_16x16x32_bf16 v[72:75], v[40:43], a[116:119], v[72:75]
  s_barrier
  v_mfma_f32_16x16x32_bf16 v[76:79], v[44:47], a[108:111], v[76:79]
  ds_read_b64_tr_b16 v[60:61], v7 offset:32768
  v_mfma_f32_16x16x32_bf16 v[80:83], v[44:47], a[112:115], v[80:83]
  ds_read_b64_tr_b16 v[62:63], v7 offset:34816
  s_add_u32 m0, s33, 4096
  v_mfma_f32_16x16x32_bf16 v[84:87], v[44:47], a[116:119], v[84:87]
  s_waitcnt lgkmcnt(6)
  s_mov_b32 s35, 16768
  v_mfma_f32_16x16x32_bf16 v[88:91], v[48:51], a[108:111], v[88:91]
  ds_read_b64_tr_b16 v[40:41], v8 offset:32768
  buffer_load_dwordx4 v24, s[12:15], s35 offen nt lds
  v_mfma_f32_16x16x32_bf16 v[92:95], v[48:51], a[112:115], v[92:95]
  ds_read_b64_tr_b16 v[42:43], v8 offset:34816
  buffer_load_dwordx4 v25, s[12:15], s35 offen offset:1024 nt lds
  v_mfma_f32_16x16x32_bf16 v[96:99], v[48:51], a[116:119], v[96:99]
  v_mfma_f32_16x16x32_bf16 v[100:103], v[52:55], a[108:111], v[100:103]
  ds_read_b64_tr_b16 v[44:45], v9 offset:32768
  v_mfma_f32_16x16x32_bf16 v[104:107], v[52:55], a[112:115], v[104:107]
  ds_read_b64_tr_b16 v[46:47], v9 offset:34816
  v_mfma_f32_16x16x32_bf16 v[108:111], v[52:55], a[116:119], v[108:111]
  s_waitcnt lgkmcnt(4)
  v_mfma_f32_16x16x32_bf16 v[112:115], v[56:59], a[108:111], v[112:115]
  ds_read_b64_tr_b16 v[48:49], v2 offset:33024
  v_mfma_f32_16x16x32_bf16 v[116:119], v[56:59], a[112:115], v[116:119]
  ds_read_b64_tr_b16 v[50:51], v2 offset:35072
  s_add_u32 m0, s33, 6144
  v_mfma_f32_16x16x32_bf16 v[120:123], v[56:59], a[116:119], v[120:123]
  s_mul_i32 s90, s80, 24576
  s_add_u32 s90, s90, s84
  v_mfma_f32_16x16x32_bf16 v[124:127], v[60:63], a[108:111], v[124:127]
  ds_read_b64_tr_b16 v[52:53], v3 offset:33024
  s_add_u32 s35, s90, 0
  v_mfma_f32_16x16x32_bf16 v[128:131], v[60:63], a[112:115], v[128:131]
  ds_read_b64_tr_b16 v[54:55], v3 offset:35072
  buffer_load_dwordx4 v28, s[64:67], s35 offen nt lds
  v_mfma_f32_16x16x32_bf16 v[132:135], v[60:63], a[116:119], v[132:135]
  s_waitcnt lgkmcnt(4)
  buffer_load_dwordx4 v29, s[64:67], s35 offen offset:1024 nt lds
  v_mfma_f32_16x16x32_bf16 v[136:139], v[40:43], a[108:111], v[136:139]
  ds_read_b64_tr_b16 v[56:57], v4 offset:33024
  v_mfma_f32_16x16x32_bf16 v[140:143], v[40:43], a[112:115], v[140:143]
  ds_read_b64_tr_b16 v[58:59], v4 offset:35072
  v_mfma_f32_16x16x32_bf16 v[144:147], v[40:43], a[116:119], v[144:147]
  v_mfma_f32_16x16x32_bf16 v[148:151], v[44:47], a[108:111], v[148:151]
  ds_read_b64_tr_b16 v[60:61], v5 offset:33024
  v_mfma_f32_16x16x32_bf16 v[152:155], v[44:47], a[112:115], v[152:155]
  ds_read_b64_tr_b16 v[62:63], v5 offset:35072
  v_mfma_f32_16x16x32_bf16 v[156:159], v[44:47], a[116:119], v[156:159]
  s_waitcnt lgkmcnt(4)
  s_add_u32 m0, s33, 8192
  v_mfma_f32_16x16x32_bf16 v[160:163], v[48:51], a[108:111], v[160:163]
  ds_read_b64_tr_b16 v[40:41], v6 offset:33024
  s_add_u32 s35, s90, 8192
  v_mfma_f32_16x16x32_bf16 v[164:167], v[48:51], a[112:115], v[164:167]
  ds_read_b64_tr_b16 v[42:43], v6 offset:35072
  buffer_load_dwordx4 v28, s[64:67], s35 offen nt lds
  v_mfma_f32_16x16x32_bf16 v[168:171], v[48:51], a[116:119], v[168:171]
  buffer_load_dwordx4 v29, s[64:67], s35 offen offset:1024 nt lds
  v_mfma_f32_16x16x32_bf16 v[172:175], v[52:55], a[108:111], v[172:175]
  ds_read_b64_tr_b16 v[44:45], v7 offset:33024
  v_mfma_f32_16x16x32_bf16 v[176:179], v[52:55], a[112:115], v[176:179]
  ds_read_b64_tr_b16 v[46:47], v7 offset:35072
  v_mfma_f32_16x16x32_bf16 v[180:183], v[52:55], a[116:119], v[180:183]
  s_waitcnt lgkmcnt(4)
  v_mfma_f32_16x16x32_bf16 v[184:187], v[56:59], a[108:111], v[184:187]
  ds_read_b64_tr_b16 v[48:49], v8 offset:33024
  v_mfma_f32_16x16x32_bf16 v[188:191], v[56:59], a[112:115], v[188:191]
  ds_read_b64_tr_b16 v[50:51], v8 offset:35072
  v_mfma_f32_16x16x32_bf16 v[192:195], v[56:59], a[116:119], v[192:195]
  s_add_u32 m0, s33, 10240
  v_mfma_f32_16x16x32_bf16 v[196:199], v[60:63], a[108:111], v[196:199]
  ds_read_b64_tr_b16 v[52:53], v9 offset:33024
  s_add_u32 s35, s90, 16384
  v_mfma_f32_16x16x32_bf16 v[200:203], v[60:63], a[112:115], v[200:203]
  ds_read_b64_tr_b16 v[54:55], v9 offset:35072
  buffer_load_dwordx4 v28, s[64:67], s35 offen nt lds
  v_mfma_f32_16x16x32_bf16 v[204:207], v[60:63], a[116:119], v[204:207]
  s_waitcnt lgkmcnt(4)
  buffer_load_dwordx4 v29, s[64:67], s35 offen offset:1024 nt lds
  v_mfma_f32_16x16x32_bf16 v[208:211], v[40:43], a[108:111], v[208:211]
  ds_read_b64_tr_b16 v[56:57], v2 offset:49152
  v_mfma_f32_16x16x32_bf16 v[212:215], v[40:43], a[112:115], v[212:215]
  ds_read_b64_tr_b16 v[58:59], v2 offset:51200
  v_mfma_f32_16x16x32_bf16 v[216:219], v[40:43], a[116:119], v[216:219]
  v_mfma_f32_16x16x32_bf16 v[220:223], v[44:47], a[108:111], v[220:223]
  ds_read_b64_tr_b16 v[60:61], v3 offset:49152
  v_mfma_f32_16x16x32_bf16 v[224:227], v[44:47], a[112:115], v[224:227]
  ds_read_b64_tr_b16 v[62:63], v3 offset:51200
  v_mfma_f32_16x16x32_bf16 v[228:231], v[44:47], a[116:119], v[228:231]
  s_waitcnt lgkmcnt(4)
  v_mfma_f32_16x16x32_bf16 v[232:235], v[48:51], a[108:111], v[232:235]
  ds_read_b64_tr_b16 v[40:41], v4 offset:49152
  v_mfma_f32_16x16x32_bf16 v[236:239], v[48:51], a[112:115], v[236:239]
  ds_read_b64_tr_b16 v[42:43], v4 offset:51200
  v_mfma_f32_16x16x32_bf16 v[240:243], v[48:51], a[116:119], v[240:243]
  v_mfma_f32_16x16x32_bf16 v[244:247], v[52:55], a[108:111], v[244:247]
  ds_read_b64_tr_b16 v[44:45], v5 offset:49152
  v_mfma_f32_16x16x32_bf16 v[248:251], v[52:55], a[112:115], v[248:251]
  ds_read_b64_tr_b16 v[46:47], v5 offset:51200
  v_mfma_f32_16x16x32_bf16 v[252:255], v[52:55], a[116:119], v[252:255]
  s_waitcnt lgkmcnt(4)
  v_mfma_f32_16x16x32_bf16 v[64:67], v[56:59], a[120:123], v[64:67]
  ds_read_b64_tr_b16 v[48:49], v6 offset:49152
  s_barrier
  v_mfma_f32_16x16x32_bf16 v[68:71], v[56:59], a[124:127], v[68:71]
  ds_read_b64_tr_b16 v[50:51], v6 offset:51200
  s_waitcnt vmcnt(10)
  v_mfma_f32_16x16x32_bf16 v[72:75], v[56:59], a[128:131], v[72:75]
  ds_read_b128 a[240:243], v26 offset:0
  ds_read_b128 a[252:255], v27 offset:0
  v_mfma_f32_16x16x32_bf16 v[76:79], v[60:63], a[120:123], v[76:79]
  ds_read_b64_tr_b16 v[52:53], v7 offset:49152
  s_waitcnt lgkmcnt(1)
  v_mfma_f32_16x16x32_bf16 v[80:83], v[60:63], a[124:127], v[80:83]
  ds_read_b64_tr_b16 v[54:55], v7 offset:51200
  s_add_u32 m0, s33, 0
  v_mfma_f32_16x16x32_bf16 v[84:87], v[60:63], a[128:131], v[84:87]
  s_mul_i32 s90, s80, 24576
  v_mfma_f32_16x16x32_bf16 v[88:91], v[40:43], a[120:123], v[88:91]
  ds_read_b64_tr_b16 v[56:57], v8 offset:49152
  s_add_u32 s90, s90, s85
  v_mfma_f32_16x16x32_bf16 v[92:95], v[40:43], a[124:127], v[92:95]
  ds_read_b64_tr_b16 v[58:59], v8 offset:51200
  s_add_u32 s35, s90, 0
  v_mfma_f32_16x16x32_bf16 v[96:99], v[40:43], a[128:131], v[96:99]
  buffer_load_dwordx4 v28, s[64:67], s35 offen nt lds
  buffer_load_dwordx4 v29, s[64:67], s35 offen offset:1024 nt lds
  v_mfma_f32_16x16x32_bf16 v[100:103], v[44:47], a[120:123], v[100:103]
  ds_read_b64_tr_b16 v[60:61], v9 offset:49152
  s_waitcnt vmcnt(10)
  v_mfma_f32_16x16x32_bf16 v[104:107], v[44:47], a[124:127], v[104:107]
  ds_read_b64_tr_b16 v[62:63], v9 offset:51200
  v_mfma_f32_16x16x32_bf16 v[108:111], v[44:47], a[128:131], v[108:111]
  s_waitcnt lgkmcnt(4)
  ds_read_b128 a[244:247], v26 offset:2048
  v_mfma_f32_16x16x32_bf16 v[112:115], v[48:51], a[120:123], v[112:115]
  ds_read_b64_tr_b16 v[40:41], v2 offset:49408
  ds_read_b128 a[0:3], v27 offset:2048
  v_mfma_f32_16x16x32_bf16 v[116:119], v[48:51], a[124:127], v[116:119]
  ds_read_b64_tr_b16 v[42:43], v2 offset:51456
  s_waitcnt lgkmcnt(1)
  v_mfma_f32_16x16x32_bf16 v[120:123], v[48:51], a[128:131], v[120:123]
  s_add_u32 m0, s33, 2048
  s_add_u32 s35, s90, 8192
  v_mfma_f32_16x16x32_bf16 v[124:127], v[52:55], a[120:123], v[124:127]
  ds_read_b64_tr_b16 v[44:45], v3 offset:49408
  buffer_load_dwordx4 v28, s[64:67], s35 offen nt lds
  v_mfma_f32_16x16x32_bf16 v[128:131], v[52:55], a[124:127], v[128:131]
  ds_read_b64_tr_b16 v[46:47], v3 offset:51456
  buffer_load_dwordx4 v29, s[64:67], s35 offen offset:1024 nt lds
  v_mfma_f32_16x16x32_bf16 v[132:135], v[52:55], a[128:131], v[132:135]
  v_mfma_f32_16x16x32_bf16 v[136:139], v[56:59], a[120:123], v[136:139]
  ds_read_b64_tr_b16 v[48:49], v4 offset:49408
  v_mfma_f32_16x16x32_bf16 v[140:143], v[56:59], a[124:127], v[140:143]
  ds_read_b64_tr_b16 v[50:51], v4 offset:51456
  s_waitcnt vmcnt(10)
  v_mfma_f32_16x16x32_bf16 v[144:147], v[56:59], a[128:131], v[144:147]
  ds_read_b128 a[248:251], v26 offset:4096
  v_mfma_f32_16x16x32_bf16 v[148:151], v[60:63], a[120:123], v[148:151]
  ds_read_b64_tr_b16 v[52:53], v5 offset:49408
  v_mfma_f32_16x16x32_bf16 v[152:155], v[60:63], a[124:127], v[152:155]
  ds_read_b64_tr_b16 v[54:55], v5 offset:51456
  ds_read_b128 a[4:7], v27 offset:4096
  v_mfma_f32_16x16x32_bf16 v[156:159], v[60:63], a[128:131], v[156:159]
  s_waitcnt lgkmcnt(6)
  s_waitcnt lgkmcnt(0)
  v_mfma_f32_16x16x32_bf16 v[160:163], v[40:43], a[120:123], v[160:163]
  ds_read_b64_tr_b16 v[56:57], v6 offset:49408
  s_add_u32 m0, s33, 4096
  v_mfma_f32_16x16x32_bf16 v[164:167], v[40:43], a[124:127], v[164:167]
  ds_read_b64_tr_b16 v[58:59], v6 offset:51456
  s_add_u32 s35, s90, 16384
  v_mfma_f32_16x16x32_bf16 v[168:171], v[40:43], a[128:131], v[168:171]
  buffer_load_dwordx4 v28, s[64:67], s35 offen nt lds
  buffer_load_dwordx4 v29, s[64:67], s35 offen offset:1024 nt lds
  v_mfma_f32_16x16x32_bf16 v[172:175], v[44:47], a[120:123], v[172:175]
  ds_read_b64_tr_b16 v[60:61], v7 offset:49408
  v_mfma_f32_16x16x32_bf16 v[176:179], v[44:47], a[124:127], v[176:179]
  ds_read_b64_tr_b16 v[62:63], v7 offset:51456
  v_mfma_f32_16x16x32_bf16 v[180:183], v[44:47], a[128:131], v[180:183]
  s_waitcnt vmcnt(10)
  v_mfma_f32_16x16x32_bf16 v[184:187], v[48:51], a[120:123], v[184:187]
  ds_read_b64_tr_b16 v[40:41], v8 offset:49408
  v_mfma_f32_16x16x32_bf16 v[188:191], v[48:51], a[124:127], v[188:191]
  ds_read_b64_tr_b16 v[42:43], v8 offset:51456
  v_mfma_f32_16x16x32_bf16 v[192:195], v[48:51], a[128:131], v[192:195]
  ds_read_b128 a[8:11], v26 offset:6144
  ds_read_b128 a[12:15], v27 offset:6144
  v_mfma_f32_16x16x32_bf16 v[196:199], v[52:55], a[120:123], v[196:199]
  ds_read_b64_tr_b16 v[44:45], v9 offset:49408
  s_add_u32 m0, s34, 0
  v_mfma_f32_16x16x32_bf16 v[200:203], v[52:55], a[124:127], v[200:203]
  ds_read_b64_tr_b16 v[46:47], v9 offset:51456
  s_mul_i32 s91, s80, 229376
  v_mfma_f32_16x16x32_bf16 v[204:207], v[52:55], a[128:131], v[204:207]
  s_waitcnt lgkmcnt(6)
  s_add_u32 s91, s91, s88
  v_mfma_f32_16x16x32_bf16 v[208:211], v[56:59], a[120:123], v[208:211]
  ds_read_b64_tr_b16 v[48:49], v10 offset:0
  buffer_load_dwordx4 v30, s[68:71], s91 offen offset:0 lds
  v_mfma_f32_16x16x32_bf16 v[212:215], v[56:59], a[124:127], v[212:215]
  ds_read_b64_tr_b16 v[50:51], v10 offset:2048
  v_mfma_f32_16x16x32_bf16 v[216:219], v[56:59], a[128:131], v[216:219]
  buffer_load_dwordx4 v31, s[68:71], s91 offen offset:1024 lds
  v_mfma_f32_16x16x32_bf16 v[220:223], v[60:63], a[120:123], v[220:223]
  ds_read_b64_tr_b16 v[52:53], v11 offset:0
  s_waitcnt vmcnt(10)
  v_mfma_f32_16x16x32_bf16 v[224:227], v[60:63], a[124:127], v[224:227]
  ds_read_b64_tr_b16 v[54:55], v11 offset:2048
  v_mfma_f32_16x16x32_bf16 v[228:231], v[60:63], a[128:131], v[228:231]
  s_waitcnt lgkmcnt(4)
  ds_read_b128 a[16:19], v26 offset:8192
  v_mfma_f32_16x16x32_bf16 v[232:235], v[40:43], a[120:123], v[232:235]
  ds_read_b64_tr_b16 v[56:57], v12 offset:0
  ds_read_b128 a[20:23], v27 offset:8192
  v_mfma_f32_16x16x32_bf16 v[236:239], v[40:43], a[124:127], v[236:239]
  ds_read_b64_tr_b16 v[58:59], v12 offset:2048
  buffer_load_dwordx4 v32, s[68:71], s91 offen offset:2048 lds
  v_mfma_f32_16x16x32_bf16 v[240:243], v[40:43], a[128:131], v[240:243]
  v_mfma_f32_16x16x32_bf16 v[244:247], v[44:47], a[120:123], v[244:247]
  ds_read_b64_tr_b16 v[60:61], v13 offset:0
  v_mfma_f32_16x16x32_bf16 v[248:251], v[44:47], a[124:127], v[248:251]
  ds_read_b64_tr_b16 v[62:63], v13 offset:2048
  v_mfma_f32_16x16x32_bf16 v[252:255], v[44:47], a[128:131], v[252:255]
  s_waitcnt lgkmcnt(6)
  v_mfma_f32_16x16x32_bf16 v[64:67], v[48:51], a[132:135], v[64:67]
  ds_read_b64_tr_b16 v[40:41], v14 offset:0
  s_barrier
  v_mfma_f32_16x16x32_bf16 v[68:71], v[48:51], a[136:139], v[68:71]
  ds_read_b64_tr_b16 v[42:43], v14 offset:2048
  buffer_load_dwordx4 v33, s[68:71], s91 offen offset:3072 lds
  v_mfma_f32_16x16x32_bf16 v[72:75], v[48:51], a[140:143], v[72:75]
  s_waitcnt vmcnt(10)
  ds_read_b128 a[24:27], v26 offset:10240
  v_mfma_f32_16x16x32_bf16 v[76:79], v[52:55], a[132:135], v[76:79]
  ds_read_b64_tr_b16 v[44:45], v15 offset:0
  v_mfma_f32_16x16x32_bf16 v[80:83], v[52:55], a[136:139], v[80:83]
  ds_read_b64_tr_b16 v[46:47], v15 offset:2048
  ds_read_b128 a[28:31], v27 offset:10240
  v_mfma_f32_16x16x32_bf16 v[84:87], v[52:55], a[140:143], v[84:87]
  s_waitcnt lgkmcnt(6)
  s_add_u32 m0, s34, 4096
  v_mfma_f32_16x16x32_bf16 v[88:91], v[56:59], a[132:135], v[88:91]
  ds_read_b64_tr_b16 v[48:49], v16 offset:0
  s_nop 0
  v_mfma_f32_16x16x32_bf16 v[92:95], v[56:59], a[136:139], v[92:95]
  ds_read_b64_tr_b16 v[50:51], v16 offset:2048
  buffer_load_dwordx4 v34, s[68:71], s91 offen offset:0 lds
  v_mfma_f32_16x16x32_bf16 v[96:99], v[56:59], a[140:143], v[96:99]
  v_mfma_f32_16x16x32_bf16 v[100:103], v[60:63], a[132:135], v[100:103]
  ds_read_b64_tr_b16 v[52:53], v17 offset:0
  v_mfma_f32_16x16x32_bf16 v[104:107], v[60:63], a[136:139], v[104:107]
  ds_read_b64_tr_b16 v[54:55], v17 offset:2048
  buffer_load_dwordx4 v35, s[68:71], s91 offen offset:1024 lds
  v_mfma_f32_16x16x32_bf16 v[108:111], v[60:63], a[140:143], v[108:111]
  s_waitcnt lgkmcnt(5)
  v_mfma_f32_16x16x32_bf16 v[112:115], v[40:43], a[132:135], v[112:115]
  ds_read_b64_tr_b16 v[56:57], v10 offset:256
  v_mfma_f32_16x16x32_bf16 v[116:119], v[40:43], a[136:139], v[116:119]
  ds_read_b64_tr_b16 v[58:59], v10 offset:2304
  v_mfma_f32_16x16x32_bf16 v[120:123], v[40:43], a[140:143], v[120:123]
  v_mfma_f32_16x16x32_bf16 v[124:127], v[44:47], a[132:135], v[124:127]
  ds_read_b64_tr_b16 v[60:61], v11 offset:256
  buffer_load_dwordx4 v36, s[68:71], s91 offen offset:2048 lds
  v_mfma_f32_16x16x32_bf16 v[128:131], v[44:47], a[136:139], v[128:131]
  ds_read_b64_tr_b16 v[62:63], v11 offset:2304
  v_mfma_f32_16x16x32_bf16 v[132:135], v[44:47], a[140:143], v[132:135]
  s_waitcnt lgkmcnt(4)
  v_mfma_f32_16x16x32_bf16 v[136:139], v[48:51], a[132:135], v[136:139]
  ds_read_b64_tr_b16 v[40:41], v12 offset:256
  v_mfma_f32_16x16x32_bf16 v[140:143], v[48:51], a[136:139], v[140:143]
  ds_read_b64_tr_b16 v[42:43], v12 offset:2304
  v_mfma_f32_16x16x32_bf16 v[144:147], v[48:51], a[140:143], v[144:147]
  s_waitcnt vmcnt(11)
  ds_read_b128 a[32:35], v26 offset:0
  v_mfma_f32_16x16x32_bf16 v[148:151], v[52:55], a[132:135], v[148:151]
  ds_read_b64_tr_b16 v[44:45], v13 offset:256
  v_mfma_f32_16x16x32_bf16 v[152:155], v[52:55], a[136:139], v[152:155]
  ds_read_b64_tr_b16 v[46:47], v13 offset:2304
  v_mfma_f32_16x16x32_bf16 v[156:159], v[52:55], a[140:143], v[156:159]
  s_waitcnt lgkmcnt(5)
  ds_read_b128 a[36:39], v27 offset:0
  v_mfma_f32_16x16x32_bf16 v[160:163], v[56:59], a[132:135], v[160:163]
  ds_read_b64_tr_b16 v[48:49], v14 offset:256
  s_add_u32 m0, s34, 28672
  v_mfma_f32_16x16x32_bf16 v[164:167], v[56:59], a[136:139], v[164:167]
  ds_read_b64_tr_b16 v[50:51], v14 offset:2304
  s_mul_i32 s91, s80, 229376
  v_mfma_f32_16x16x32_bf16 v[168:171], v[56:59], a[140:143], v[168:171]
  s_add_u32 s91, s91, s89
  buffer_load_dwordx4 v30, s[68:71], s91 offen offset:0 lds
  v_mfma_f32_16x16x32_bf16 v[172:175], v[60:63], a[132:135], v[172:175]
  ds_read_b64_tr_b16 v[52:53], v15 offset:256
  buffer_load_dwordx4 v31, s[68:71], s91 offen offset:1024 lds
  v_mfma_f32_16x16x32_bf16 v[176:179], v[60:63], a[136:139], v[176:179]
  ds_read_b64_tr_b16 v[54:55], v15 offset:2304
  v_mfma_f32_16x16x32_bf16 v[180:183], v[60:63], a[140:143], v[180:183]
  s_waitcnt lgkmcnt(5)
  v_mfma_f32_16x16x32_bf16 v[184:187], v[40:43], a[132:135], v[184:187]
  ds_read_b64_tr_b16 v[56:57], v16 offset:256
  s_waitcnt vmcnt(11)
  v_mfma_f32_16x16x32_bf16 v[188:191], v[40:43], a[136:139], v[188:191]
  ds_read_b64_tr_b16 v[58:59], v16 offset:2304
  v_mfma_f32_16x16x32_bf16 v[192:195], v[40:43], a[140:143], v[192:195]
  ds_read_b128 a[40:43], v26 offset:2048
  v_mfma_f32_16x16x32_bf16 v[196:199], v[44:47], a[132:135], v[196:199]
  ds_read_b64_tr_b16 v[60:61], v17 offset:256
  ds_read_b128 a[44:47], v27 offset:2048
  v_mfma_f32_16x16x32_bf16 v[200:203], v[44:47], a[136:139], v[200:203]
  ds_read_b64_tr_b16 v[62:63], v17 offset:2304
  buffer_load_dwordx4 v32, s[68:71], s91 offen offset:2048 lds
  v_mfma_f32_16x16x32_bf16 v[204:207], v[44:47], a[140:143], v[204:207]
  s_waitcnt lgkmcnt(6)
  buffer_load_dwordx4 v33, s[68:71], s91 offen offset:3072 lds
  v_mfma_f32_16x16x32_bf16 v[208:211], v[48:51], a[132:135], v[208:211]
  ds_read_b64_tr_b16 v[40:41], v10 offset:16384
  v_mfma_f32_16x16x32_bf16 v[212:215], v[48:51], a[136:139], v[212:215]
  ds_read_b64_tr_b16 v[42:43], v10 offset:18432
  v_mfma_f32_16x16x32_bf16 v[216:219], v[48:51], a[140:143], v[216:219]
  v_mfma_f32_16x16x32_bf16 v[220:223], v[52:55], a[132:135], v[220:223]
  ds_read_b64_tr_b16 v[44:45], v11 offset:16384
  v_mfma_f32_16x16x32_bf16 v[224:227], v[52:55], a[136:139], v[224:227]
  ds_read_b64_tr_b16 v[46:47], v11 offset:18432
  s_waitcnt vmcnt(11)
  v_mfma_f32_16x16x32_bf16 v[228:231], v[52:55], a[140:143], v[228:231]
  s_waitcnt lgkmcnt(4)
  ds_read_b128 a[48:51], v26 offset:4096
  v_mfma_f32_16x16x32_bf16 v[232:235], v[56:59], a[132:135], v[232:235]
  ds_read_b64_tr_b16 v[48:49], v12 offset:16384
  v_mfma_f32_16x16x32_bf16 v[236:239], v[56:59], a[136:139], v[236:239]
  ds_read_b64_tr_b16 v[50:51], v12 offset:18432
  ds_read_b128 a[52:55], v27 offset:4096
  v_mfma_f32_16x16x32_bf16 v[240:243], v[56:59], a[140:143], v[240:243]
  s_add_u32 m0, s34, 32768
  s_nop 0
  v_mfma_f32_16x16x32_bf16 v[244:247], v[60:63], a[132:135], v[244:247]
  ds_read_b64_tr_b16 v[52:53], v13 offset:16384
  buffer_load_dwordx4 v34, s[68:71], s91 offen offset:0 lds
  v_mfma_f32_16x16x32_bf16 v[248:251], v[60:63], a[136:139], v[248:251]
  ds_read_b64_tr_b16 v[54:55], v13 offset:18432
  buffer_load_dwordx4 v35, s[68:71], s91 offen offset:1024 lds
  v_mfma_f32_16x16x32_bf16 v[252:255], v[60:63], a[140:143], v[252:255]
  s_waitcnt lgkmcnt(6)
  v_mfma_f32_16x16x32_bf16 v[64:67], v[40:43], a[144:147], v[64:67]
  ds_read_b64_tr_b16 v[56:57], v14 offset:16384
  s_barrier
  v_mfma_f32_16x16x32_bf16 v[68:71], v[40:43], a[148:151], v[68:71]
  ds_read_b64_tr_b16 v[58:59], v14 offset:18432
  v_mfma_f32_16x16x32_bf16 v[72:75], v[40:43], a[152:155], v[72:75]
  buffer_load_dwordx4 v36, s[68:71], s91 offen offset:2048 lds
  v_mfma_f32_16x16x32_bf16 v[76:79], v[44:47], a[144:147], v[76:79]
  ds_read_b64_tr_b16 v[60:61], v15 offset:16384
  v_mfma_f32_16x16x32_bf16 v[80:83], v[44:47], a[148:151], v[80:83]
  ds_read_b64_tr_b16 v[62:63], v15 offset:18432
  v_mfma_f32_16x16x32_bf16 v[84:87], v[44:47], a[152:155], v[84:87]
  s_waitcnt lgkmcnt(4)
  v_mfma_f32_16x16x32_bf16 v[88:91], v[48:51], a[144:147], v[88:91]
  ds_read_b64_tr_b16 v[40:41], v16 offset:16384
  v_mfma_f32_16x16x32_bf16 v[92:95], v[48:51], a[148:151], v[92:95]
  ds_read_b64_tr_b16 v[42:43], v16 offset:18432
  v_mfma_f32_16x16x32_bf16 v[96:99], v[48:51], a[152:155], v[96:99]
  s_add_u32 m0, s33, 6144
  s_mul_i32 s90, s80, 24576
  v_mfma_f32_16x16x32_bf16 v[100:103], v[52:55], a[144:147], v[100:103]
  ds_read_b64_tr_b16 v[44:45], v17 offset:16384
  s_add_u32 s90, s90, s86
  v_mfma_f32_16x16x32_bf16 v[104:107], v[52:55], a[148:151], v[104:107]
  ds_read_b64_tr_b16 v[46:47], v17 offset:18432
  s_add_u32 s35, s90, 0
  v_mfma_f32_16x16x32_bf16 v[108:111], v[52:55], a[152:155], v[108:111]
  s_waitcnt lgkmcnt(4)
  buffer_load_dwordx4 v28, s[64:67], s35 offen nt lds
  v_mfma_f32_16x16x32_bf16 v[112:115], v[56:59], a[144:147], v[112:115]
  ds_read_b64_tr_b16 v[48:49], v10 offset:16640
  buffer_load_dwordx4 v29, s[64:67], s35 offen offset:1024 nt lds
  v_mfma_f32_16x16x32_bf16 v[116:119], v[56:59], a[148:151], v[116:119]
  ds_read_b64_tr_b16 v[50:51], v10 offset:18688
  v_mfma_f32_16x16x32_bf16 v[120:123], v[56:59], a[152:155], v[120:123]
  v_mfma_f32_16x16x32_bf16 v[124:127], v[60:63], a[144:147], v[124:127]
  ds_read_b64_tr_b16 v[52:53], v11 offset:16640
  v_mfma_f32_16x16x32_bf16 v[128:131], v[60:63], a[148:151], v[128:131]
  ds_read_b64_tr_b16 v[54:55], v11 offset:18688
  v_mfma_f32_16x16x32_bf16 v[132:135], v[60:63], a[152:155], v[132:135]
  s_waitcnt lgkmcnt(4)
  v_mfma_f32_16x16x32_bf16 v[136:139], v[40:43], a[144:147], v[136:139]
  ds_read_b64_tr_b16 v[56:57], v12 offset:16640
  s_add_u32 m0, s33, 8192
  v_mfma_f32_16x16x32_bf16 v[140:143], v[40:43], a[148:151], v[140:143]
  ds_read_b64_tr_b16 v[58:59], v12 offset:18688
  s_add_u32 s35, s90, 8192
  v_mfma_f32_16x16x32_bf16 v[144:147], v[40:43], a[152:155], v[144:147]
  buffer_load_dwordx4 v28, s[64:67], s35 offen nt lds
  buffer_load_dwordx4 v29, s[64:67], s35 offen offset:1024 nt lds
  v_mfma_f32_16x16x32_bf16 v[148:151], v[44:47], a[144:147], v[148:151]
  ds_read_b64_tr_b16 v[60:61], v13 offset:16640
  v_mfma_f32_16x16x32_bf16 v[152:155], v[44:47], a[148:151], v[152:155]
  ds_read_b64_tr_b16 v[62:63], v13 offset:18688
  v_mfma_f32_16x16x32_bf16 v[156:159], v[44:47], a[152:155], v[156:159]
  s_waitcnt lgkmcnt(4)
  v_mfma_f32_16x16x32_bf16 v[160:163], v[48:51], a[144:147], v[160:163]
  ds_read_b64_tr_b16 v[40:41], v14 offset:16640
  v_mfma_f32_16x16x32_bf16 v[164:167], v[48:51], a[148:151], v[164:167]
  ds_read_b64_tr_b16 v[42:43], v14 offset:18688
  v_mfma_f32_16x16x32_bf16 v[168:171], v[48:51], a[152:155], v[168:171]
  v_mfma_f32_16x16x32_bf16 v[172:175], v[52:55], a[144:147], v[172:175]
  ds_read_b64_tr_b16 v[44:45], v15 offset:16640
  v_mfma_f32_16x16x32_bf16 v[176:179], v[52:55], a[148:151], v[176:179]
  ds_read_b64_tr_b16 v[46:47], v15 offset:18688
  s_add_u32 m0, s33, 10240
  v_mfma_f32_16x16x32_bf16 v[180:183], v[52:55], a[152:155], v[180:183]
  s_waitcnt lgkmcnt(4)
  s_add_u32 s35, s90, 16384
  v_mfma_f32_16x16x32_bf16 v[184:187], v[56:59], a[144:147], v[184:187]
  ds_read_b64_tr_b16 v[48:49], v16 offset:16640
  buffer_load_dwordx4 v28, s[64:67], s35 offen nt lds
  v_mfma_f32_16x16x32_bf16 v[188:191], v[56:59], a[148:151], v[188:191]
  ds_read_b64_tr_b16 v[50:51], v16 offset:18688
  buffer_load_dwordx4 v29, s[64:67], s35 offen offset:1024 nt lds
  v_mfma_f32_16x16x32_bf16 v[192:195], v[56:59], a[152:155], v[192:195]
  v_mfma_f32_16x16x32_bf16 v[196:199], v[60:63], a[144:147], v[196:199]
  ds_read_b64_tr_b16 v[52:53], v17 offset:16640
  v_mfma_f32_16x16x32_bf16 v[200:203], v[60:63], a[148:151], v[200:203]
  ds_read_b64_tr_b16 v[54:55], v17 offset:18688
  v_mfma_f32_16x16x32_bf16 v[204:207], v[60:63], a[152:155], v[204:207]
  s_waitcnt lgkmcnt(4)
  v_mfma_f32_16x16x32_bf16 v[208:211], v[40:43], a[144:147], v[208:211]
  ds_read_b64_tr_b16 v[56:57], v10 offset:32768
  v_mfma_f32_16x16x32_bf16 v[212:215], v[40:43], a[148:151], v[212:215]
  ds_read_b64_tr_b16 v[58:59], v10 offset:34816
  v_mfma_f32_16x16x32_bf16 v[216:219], v[40:43], a[152:155], v[216:219]
  s_add_u32 m0, s33, 0
  s_mul_i32 s90, s80, 24576
  v_mfma_f32_16x16x32_bf16 v[220:223], v[44:47], a[144:147], v[220:223]
  ds_read_b64_tr_b16 v[60:61], v11 offset:32768
  s_add_u32 s90, s90, s87
  v_mfma_f32_16x16x32_bf16 v[224:227], v[44:47], a[148:151], v[224:227]
  ds_read_b64_tr_b16 v[62:63], v11 offset:34816
  s_add_u32 s35, s90, 0
  v_mfma_f32_16x16x32_bf16 v[228:231], v[44:47], a[152:155], v[228:231]
  s_waitcnt lgkmcnt(4)
  buffer_load_dwordx4 v28, s[64:67], s35 offen nt lds
  v_mfma_f32_16x16x32_bf16 v[232:235], v[48:51], a[144:147], v[232:235]
  ds_read_b64_tr_b16 v[40:41], v12 offset:32768
  buffer_load_dwordx4 v29, s[64:67], s35 offen offset:1024 nt lds
  v_mfma_f32_16x16x32_bf16 v[236:239], v[48:51], a[148:151], v[236:239]
  ds_read_b64_tr_b16 v[42:43], v12 offset:34816
  v_mfma_f32_16x16x32_bf16 v[240:243], v[48:51], a[152:155], v[240:243]
  v_mfma_f32_16x16x32_bf16 v[244:247], v[52:55], a[144:147], v[244:247]
  ds_read_b64_tr_b16 v[44:45], v13 offset:32768
  v_mfma_f32_16x16x32_bf16 v[248:251], v[52:55], a[148:151], v[248:251]
  ds_read_b64_tr_b16 v[46:47], v13 offset:34816
  v_mfma_f32_16x16x32_bf16 v[252:255], v[52:55], a[152:155], v[252:255]
  s_waitcnt lgkmcnt(4)
  s_barrier
  v_mfma_f32_16x16x32_bf16 v[64:67], v[56:59], a[156:159], v[64:67]
  ds_read_b64_tr_b16 v[48:49], v14 offset:32768
  v_mfma_f32_16x16x32_bf16 v[68:71], v[56:59], a[160:163], v[68:71]
  ds_read_b64_tr_b16 v[50:51], v14 offset:34816
  s_add_u32 m0, s33, 2048
  v_mfma_f32_16x16x32_bf16 v[72:75], v[56:59], a[164:167], v[72:75]
  s_add_u32 s35, s90, 8192
  buffer_load_dwordx4 v28, s[64:67], s35 offen nt lds
  v_mfma_f32_16x16x32_bf16 v[76:79], v[60:63], a[156:159], v[76:79]
  ds_read_b64_tr_b16 v[52:53], v15 offset:32768
  buffer_load_dwordx4 v29, s[64:67], s35 offen offset:1024 nt lds
  v_mfma_f32_16x16x32_bf16 v[80:83], v[60:63], a[160:163], v[80:83]
  ds_read_b64_tr_b16 v[54:55], v15 offset:34816
  v_mfma_f32_16x16x32_bf16 v[84:87], v[60:63], a[164:167], v[84:87]
  s_waitcnt lgkmcnt(4)
  v_mfma_f32_16x16x32_bf16 v[88:91], v[40:43], a[156:159], v[88:91]
  ds_read_b64_tr_b16 v[56:57], v16 offset:32768
  v_mfma_f32_16x16x32_bf16 v[92:95], v[40:43], a[160:163], v[92:95]
  ds_read_b64_tr_b16 v[58:59], v16 offset:34816
  v_mfma_f32_16x16x32_bf16 v[96:99], v[40:43], a[164:167], v[96:99]
  v_mfma_f32_16x16x32_bf16 v[100:103], v[44:47], a[156:159], v[100:103]
  ds_read_b64_tr_b16 v[60:61], v17 offset:32768
  v_mfma_f32_16x16x32_bf16 v[104:107], v[44:47], a[160:163], v[104:107]
  ds_read_b64_tr_b16 v[62:63], v17 offset:34816
  s_add_u32 m0, s33, 4096
  v_mfma_f32_16x16x32_bf16 v[108:111], v[44:47], a[164:167], v[108:111]
  s_waitcnt lgkmcnt(4)
  s_add_u32 s35, s90, 16384
  v_mfma_f32_16x16x32_bf16 v[112:115], v[48:51], a[156:159], v[112:115]
  ds_read_b64_tr_b16 v[40:41], v10 offset:33024
  buffer_load_dwordx4 v28, s[64:67], s35 offen nt lds
  v_mfma_f32_16x16x32_bf16 v[116:119], v[48:51], a[160:163], v[116:119]
  ds_read_b64_tr_b16 v[42:43], v10 offset:35072
  buffer_load_dwordx4 v29, s[64:67], s35 offen offset:1024 nt lds
  v_mfma_f32_16x16x32_bf16 v[120:123], v[48:51], a[164:167], v[120:123]
  v_cvt_pk_bf16_f32 v64, v64, v65
  v_cvt_pk_bf16_f32 v65, v66, v67
  v_mfma_f32_16x16x32_bf16 v[124:127], v[52:55], a[156:159], v[124:127]
  ds_read_b64_tr_b16 v[44:45], v11 offset:33024
  v_cvt_pk_bf16_f32 v66, v76, v77
  v_mfma_f32_16x16x32_bf16 v[128:131], v[52:55], a[160:163], v[128:131]
  ds_read_b64_tr_b16 v[46:47], v11 offset:35072
  v_cvt_pk_bf16_f32 v67, v78, v79
  v_mfma_f32_16x16x32_bf16 v[132:135], v[52:55], a[164:167], v[132:135]
  s_waitcnt lgkmcnt(4)
  v_cvt_pk_bf16_f32 v68, v68, v69
  v_mfma_f32_16x16x32_bf16 v[136:139], v[56:59], a[156:159], v[136:139]
  ds_read_b64_tr_b16 v[48:49], v12 offset:33024
  v_cvt_pk_bf16_f32 v69, v70, v71
  v_mfma_f32_16x16x32_bf16 v[140:143], v[56:59], a[160:163], v[140:143]
  ds_read_b64_tr_b16 v[50:51], v12 offset:35072
  v_cvt_pk_bf16_f32 v70, v80, v81
  v_cvt_pk_bf16_f32 v71, v82, v83
  v_mfma_f32_16x16x32_bf16 v[144:147], v[56:59], a[164:167], v[144:147]
  v_cvt_pk_bf16_f32 v72, v72, v73
  v_cvt_pk_bf16_f32 v73, v74, v75
  v_mfma_f32_16x16x32_bf16 v[148:151], v[60:63], a[156:159], v[148:151]
  ds_read_b64_tr_b16 v[52:53], v13 offset:33024
  v_cvt_pk_bf16_f32 v74, v84, v85
  v_cvt_pk_bf16_f32 v75, v86, v87
  v_mfma_f32_16x16x32_bf16 v[152:155], v[60:63], a[160:163], v[152:155]
  ds_read_b64_tr_b16 v[54:55], v13 offset:35072
  s_mov_b64 exec, s[28:29]
  v_swap_b32 v64, v66
  v_swap_b32 v65, v67
  v_swap_b32 v68, v70
  v_swap_b32 v69, v71
  v_swap_b32 v72, v74
  v_swap_b32 v73, v75
  s_mov_b64 exec, -1
  buffer_load_dword v39, off, s[76:79], 0 sc1
  v_mfma_f32_16x16x32_bf16 v[156:159], v[60:63], a[164:167], v[156:159]
  s_waitcnt lgkmcnt(4)
  v_cvt_pk_bf16_f32 v88, v88, v89
  v_mfma_f32_16x16x32_bf16 v[160:163], v[40:43], a[156:159], v[160:163]
  ds_read_b64_tr_b16 v[56:57], v14 offset:33024
  v_cvt_pk_bf16_f32 v89, v90, v91
  v_mfma_f32_16x16x32_bf16 v[164:167], v[40:43], a[160:163], v[164:167]
  ds_read_b64_tr_b16 v[58:59], v14 offset:35072
  v_cvt_pk_bf16_f32 v90, v100, v101
  v_mfma_f32_16x16x32_bf16 v[168:171], v[40:43], a[164:167], v[168:171]
  v_cvt_pk_bf16_f32 v91, v102, v103
  v_cvt_pk_bf16_f32 v92, v92, v93
  v_mfma_f32_16x16x32_bf16 v[172:175], v[44:47], a[156:159], v[172:175]
  ds_read_b64_tr_b16 v[60:61], v15 offset:33024
  v_cvt_pk_bf16_f32 v93, v94, v95
  v_cvt_pk_bf16_f32 v94, v104, v105
  v_cvt_pk_bf16_f32 v95, v106, v107
  v_cvt_pk_bf16_f32 v96, v96, v97
  v_cvt_pk_bf16_f32 v97, v98, v99
  v_cvt_pk_bf16_f32 v98, v108, v109
  v_cvt_pk_bf16_f32 v99, v110, v111
  s_waitcnt vmcnt(11)
  ds_read_b128 a[132:135], v26 offset:6144
  ds_read_b128 a[136:139], v27 offset:6144
  v_mfma_f32_16x16x32_bf16 v[176:179], v[44:47], a[160:163], v[176:179]
  ds_read_b64_tr_b16 v[62:63], v15 offset:35072
  v_mfma_f32_16x16x32_bf16 v[180:183], v[44:47], a[164:167], v[180:183]
  s_waitcnt lgkmcnt(6)
  s_mov_b64 exec, s[28:29]
  v_swap_b32 v88, v90
  v_swap_b32 v89, v91
  v_swap_b32 v92, v94
  v_swap_b32 v93, v95
  v_swap_b32 v96, v98
  v_swap_b32 v97, v99
  s_mov_b64 exec, -1
  v_mfma_f32_16x16x32_bf16 v[184:187], v[48:51], a[156:159], v[184:187]
  ds_read_b64_tr_b16 v[40:41], v16 offset:33024
  v_cvt_pk_bf16_f32 v112, v112, v113
  v_mfma_f32_16x16x32_bf16 v[188:191], v[48:51], a[160:163], v[188:191]
  ds_read_b64_tr_b16 v[42:43], v16 offset:35072
  v_cvt_pk_bf16_f32 v113, v114, v115
  v_mfma_f32_16x16x32_bf16 v[192:195], v[48:51], a[164:167], v[192:195]
  s_waitcnt lgkmcnt(3)
  s_add_u32 m0, s33, 6144
  v_mfma_f32_16x16x32_bf16 v[196:199], v[52:55], a[156:159], v[196:199]
  ds_read_b64_tr_b16 v[44:45], v17 offset:33024
  s_mul_i32 s90, s81, 24576
  v_mfma_f32_16x16x32_bf16 v[200:203], v[52:55], a[160:163], v[200:203]
  ds_read_b64_tr_b16 v[46:47], v17 offset:35072
  s_add_u32 s90, s90, s84
  s_add_u32 s35, s90, 0
  buffer_load_dwordx4 v28, s[64:67], s35 offen nt lds
  buffer_load_dwordx4 v29, s[64:67], s35 offen offset:1024 nt lds
  v_mfma_f32_16x16x32_bf16 v[204:207], v[52:55], a[164:167], v[204:207]
  s_waitcnt lgkmcnt(4)
  v_cvt_pk_bf16_f32 v114, v124, v125
  v_cvt_pk_bf16_f32 v115, v126, v127
  v_mfma_f32_16x16x32_bf16 v[208:211], v[56:59], a[156:159], v[208:211]
  v_cvt_pk_bf16_f32 v116, v116, v117
  v_cvt_pk_bf16_f32 v117, v118, v119
  v_mfma_f32_16x16x32_bf16 v[212:215], v[56:59], a[160:163], v[212:215]
  v_cvt_pk_bf16_f32 v118, v128, v129
  v_cvt_pk_bf16_f32 v119, v130, v131
  v_cvt_pk_bf16_f32 v120, v120, v121
  v_cvt_pk_bf16_f32 v121, v122, v123
  v_cvt_pk_bf16_f32 v122, v132, v133
  v_cvt_pk_bf16_f32 v123, v134, v135
  s_mov_b64 exec, s[28:29]
  v_swap_b32 v112, v114
  v_swap_b32 v113, v115
  v_swap_b32 v116, v118
  v_swap_b32 v117, v119
  v_swap_b32 v120, v122
  v_swap_b32 v121, v123
  s_mov_b64 exec, -1
  s_waitcnt vmcnt(11)
  ds_read_b128 a[140:143], v26 offset:8192
  ds_read_b128 a[144:147], v27 offset:8192
  v_mfma_f32_16x16x32_bf16 v[216:219], v[56:59], a[164:167], v[216:219]
  v_cvt_pk_bf16_f32 v136, v136, v137
  v_cvt_pk_bf16_f32 v137, v138, v139
  v_mfma_f32_16x16x32_bf16 v[220:223], v[60:63], a[156:159], v[220:223]
  v_cvt_pk_bf16_f32 v138, v148, v149
  v_cvt_pk_bf16_f32 v139, v150, v151
  v_mfma_f32_16x16x32_bf16 v[224:227], v[60:63], a[160:163], v[224:227]
  s_waitcnt lgkmcnt(0)
  s_add_u32 m0, s33, 8192
  v_mfma_f32_16x16x32_bf16 v[228:231], v[60:63], a[164:167], v[228:231]
  s_add_u32 s35, s90, 8192
  v_mfma_f32_16x16x32_bf16 v[232:235], v[40:43], a[156:159], v[232:235]
  buffer_load_dwordx4 v28, s[64:67], s35 offen nt lds
  buffer_load_dwordx4 v29, s[64:67], s35 offen offset:1024 nt lds
  v_mfma_f32_16x16x32_bf16 v[236:239], v[40:43], a[160:163], v[236:239]
  v_cvt_pk_bf16_f32 v140, v140, v141
  v_cvt_pk_bf16_f32 v141, v142, v143
  v_mfma_f32_16x16x32_bf16 v[240:243], v[40:43], a[164:167], v[240:243]
  v_cvt_pk_bf16_f32 v142, v152, v153
  v_cvt_pk_bf16_f32 v143, v154, v155
  v_mfma_f32_16x16x32_bf16 v[244:247], v[44:47], a[156:159], v[244:247]
  v_cvt_pk_bf16_f32 v144, v144, v145
  v_cvt_pk_bf16_f32 v145, v146, v147
  v_mfma_f32_16x16x32_bf16 v[248:251], v[44:47], a[160:163], v[248:251]
  v_cvt_pk_bf16_f32 v146, v156, v157
  v_cvt_pk_bf16_f32 v147, v158, v159
  v_mfma_f32_16x16x32_bf16 v[252:255], v[44:47], a[164:167], v[252:255]
  s_mov_b64 exec, s[28:29]
  v_swap_b32 v136, v138
  v_swap_b32 v137, v139
  v_swap_b32 v140, v142
  v_swap_b32 v141, v143
  v_swap_b32 v144, v146
  v_swap_b32 v145, v147
  s_mov_b64 exec, -1
  s_waitcnt vmcnt(11)
  ds_read_b128 a[148:151], v26 offset:10240
  ds_read_b128 a[152:155], v27 offset:10240
  v_mfma_f32_16x16x32_bf16 v[76:79], a[168:171], v[64:67], 0
  v_cvt_pk_bf16_f32 v160, v160, v161
  v_cvt_pk_bf16_f32 v161, v162, v163
  v_mfma_f32_16x16x32_bf16 v[100:103], a[172:175], v[64:67], 0
  v_cvt_pk_bf16_f32 v162, v172, v173
  v_cvt_pk_bf16_f32 v163, v174, v175
  v_mfma_f32_16x16x32_bf16 v[124:127], a[176:179], v[64:67], 0
  v_cvt_pk_bf16_f32 v164, v164, v165
  v_cvt_pk_bf16_f32 v165, v166, v167
  v_mfma_f32_16x16x32_bf16 v[80:83], a[168:171], v[68:71], 0
  s_waitcnt lgkmcnt(0)
  s_add_u32 m0, s33, 10240
  v_mfma_f32_16x16x32_bf16 v[104:107], a[172:175], v[68:71], 0
  s_add_u32 s35, s90, 16384
  buffer_load_dwordx4 v28, s[64:67], s35 offen nt lds
  v_mfma_f32_16x16x32_bf16 v[128:131], a[176:179], v[68:71], 0
  buffer_load_dwordx4 v29, s[64:67], s35 offen offset:1024 nt lds
  v_cvt_pk_bf16_f32 v166, v176, v177
  v_mfma_f32_16x16x32_bf16 v[84:87], a[168:171], v[72:75], 0
  v_cvt_pk_bf16_f32 v167, v178, v179
  v_cvt_pk_bf16_f32 v168, v168, v169
  v_mfma_f32_16x16x32_bf16 v[108:111], a[172:175], v[72:75], 0
  v_cvt_pk_bf16_f32 v169, v170, v171
  v_cvt_pk_bf16_f32 v170, v180, v181
  v_mfma_f32_16x16x32_bf16 v[132:135], a[176:179], v[72:75], 0
  v_cvt_pk_bf16_f32 v171, v182, v183
  v_mfma_f32_16x16x32_bf16 v[76:79], a[180:183], v[88:91], v[76:79]
  s_mov_b64 exec, s[28:29]
  v_swap_b32 v160, v162
  v_swap_b32 v161, v163
  v_swap_b32 v164, v166
  v_swap_b32 v165, v167
  v_swap_b32 v168, v170
  v_swap_b32 v169, v171
  s_mov_b64 exec, -1
  s_waitcnt vmcnt(11)
  ds_read_b128 a[156:159], v26 offset:0
  ds_read_b128 a[160:163], v27 offset:0
  v_mfma_f32_16x16x32_bf16 v[100:103], a[184:187], v[88:91], v[100:103]
  v_cvt_pk_bf16_f32 v184, v184, v185
  v_cvt_pk_bf16_f32 v185, v186, v187
  v_mfma_f32_16x16x32_bf16 v[124:127], a[188:191], v[88:91], v[124:127]
  v_cvt_pk_bf16_f32 v186, v196, v197
  v_cvt_pk_bf16_f32 v187, v198, v199
  v_mfma_f32_16x16x32_bf16 v[80:83], a[180:183], v[92:95], v[80:83]
  v_cvt_pk_bf16_f32 v188, v188, v189
  v_cvt_pk_bf16_f32 v189, v190, v191
  v_mfma_f32_16x16x32_bf16 v[104:107], a[184:187], v[92:95], v[104:107]
  v_cvt_pk_bf16_f32 v190, v200, v201
  v_cvt_pk_bf16_f32 v191, v202, v203
  v_mfma_f32_16x16x32_bf16 v[128:131], a[188:191], v[92:95], v[128:131]
  s_waitcnt lgkmcnt(0)
  s_add_u32 m0, s33, 0
  v_mfma_f32_16x16x32_bf16 v[84:87], a[180:183], v[96:99], v[84:87]
  s_mul_i32 s90, s81, 24576
  s_add_u32 s90, s90, s85
  v_mfma_f32_16x16x32_bf16 v[108:111], a[184:187], v[96:99], v[108:111]
  s_add_u32 s35, s90, 0
  buffer_load_dwordx4 v28, s[64:67], s35 offen nt lds
  buffer_load_dwordx4 v29, s[64:67], s35 offen offset:1024 nt lds
  v_mfma_f32_16x16x32_bf16 v[132:135], a[188:191], v[96:99], v[132:135]
  v_cvt_pk_bf16_f32 v192, v192, v193
  v_cvt_pk_bf16_f32 v193, v194, v195
  v_mfma_f32_16x16x32_bf16 v[76:79], a[192:195], v[112:115], v[76:79]
  v_cvt_pk_bf16_f32 v194, v204, v205
  v_cvt_pk_bf16_f32 v195, v206, v207
  v_mfma_f32_16x16x32_bf16 v[100:103], a[196:199], v[112:115], v[100:103]
  s_mov_b64 exec, s[28:29]
  v_swap_b32 v184, v186
  v_swap_b32 v185, v187
  v_swap_b32 v188, v190
  v_swap_b32 v189, v191
  v_swap_b32 v192, v194
  v_swap_b32 v193, v195
  s_mov_b64 exec, -1
  v_cvt_pk_bf16_f32 v208, v208, v209
  v_cvt_pk_bf16_f32 v209, v210, v211
  s_waitcnt vmcnt(11)
  ds_read_b128 a[164:167], v26 offset:2048
  ds_read_b128 a[168:171], v27 offset:2048
  v_mfma_f32_16x16x32_bf16 v[124:127], a[200:203], v[112:115], v[124:127]
  v_cvt_pk_bf16_f32 v210, v220, v221
  v_cvt_pk_bf16_f32 v211, v222, v223
  v_mfma_f32_16x16x32_bf16 v[80:83], a[192:195], v[116:119], v[80:83]
  v_cvt_pk_bf16_f32 v212, v212, v213
  v_cvt_pk_bf16_f32 v213, v214, v215
  v_mfma_f32_16x16x32_bf16 v[104:107], a[196:199], v[116:119], v[104:107]
  v_cvt_pk_bf16_f32 v214, v224, v225
  v_cvt_pk_bf16_f32 v215, v226, v227
  v_mfma_f32_16x16x32_bf16 v[128:131], a[200:203], v[116:119], v[128:131]
  v_cvt_pk_bf16_f32 v216, v216, v217
  v_cvt_pk_bf16_f32 v217, v218, v219
  v_mfma_f32_16x16x32_bf16 v[84:87], a[192:195], v[120:123], v[84:87]
  s_waitcnt lgkmcnt(0)
  s_add_u32 m0, s33, 2048
  v_mfma_f32_16x16x32_bf16 v[108:111], a[196:199], v[120:123], v[108:111]
  s_add_u32 s35, s90, 8192
  buffer_load_dwordx4 v28, s[64:67], s35 offen nt lds
  v_mfma_f32_16x16x32_bf16 v[132:135], a[200:203], v[120:123], v[132:135]
  buffer_load_dwordx4 v29, s[64:67], s35 offen offset:1024 nt lds
  v_cvt_pk_bf16_f32 v218, v228, v229
  v_mfma_f32_16x16x32_bf16 v[76:79], a[204:207], v[136:139], v[76:79]
  v_cvt_pk_bf16_f32 v219, v230, v231
  v_mfma_f32_16x16x32_bf16 v[100:103], a[208:211], v[136:139], v[100:103]
  s_mov_b64 exec, s[28:29]
  v_swap_b32 v208, v210
  v_swap_b32 v209, v211
  v_swap_b32 v212, v214
  v_swap_b32 v213, v215
  v_swap_b32 v216, v218
  v_swap_b32 v217, v219
  s_mov_b64 exec, -1
  v_mfma_f32_16x16x32_bf16 v[124:127], a[212:215], v[136:139], v[124:127]
  v_cvt_pk_bf16_f32 v232, v232, v233
  v_cvt_pk_bf16_f32 v233, v234, v235
  v_cvt_pk_bf16_f32 v234, v244, v245
  v_cvt_pk_bf16_f32 v235, v246, v247
  s_waitcnt vmcnt(11)
  ds_read_b128 a[172:175], v26 offset:4096
  ds_read_b128 a[176:179], v27 offset:4096
  v_mfma_f32_16x16x32_bf16 v[80:83], a[204:207], v[140:143], v[80:83]
  v_cvt_pk_bf16_f32 v236, v236, v237
  v_cvt_pk_bf16_f32 v237, v238, v239
  v_mfma_f32_16x16x32_bf16 v[104:107], a[208:211], v[140:143], v[104:107]
  v_cvt_pk_bf16_f32 v238, v248, v249
  v_cvt_pk_bf16_f32 v239, v250, v251
  v_mfma_f32_16x16x32_bf16 v[128:131], a[212:215], v[140:143], v[128:131]
  v_cvt_pk_bf16_f32 v240, v240, v241
  v_cvt_pk_bf16_f32 v241, v242, v243
  v_mfma_f32_16x16x32_bf16 v[84:87], a[204:207], v[144:147], v[84:87]
  v_cvt_pk_bf16_f32 v242, v252, v253
  v_cvt_pk_bf16_f32 v243, v254, v255
  v_mfma_f32_16x16x32_bf16 v[108:111], a[208:211], v[144:147], v[108:111]
  s_waitcnt lgkmcnt(0)
  s_add_u32 m0, s33, 4096
  v_mfma_f32_16x16x32_bf16 v[132:135], a[212:215], v[144:147], v[132:135]
  s_add_u32 s35, s90, 16384
  buffer_load_dwordx4 v28, s[64:67], s35 offen nt lds
  v_mfma_f32_16x16x32_bf16 v[76:79], a[216:219], v[160:163], v[76:79]
  buffer_load_dwordx4 v29, s[64:67], s35 offen offset:1024 nt lds
  v_mfma_f32_16x16x32_bf16 v[100:103], a[220:223], v[160:163], v[100:103]
  s_mov_b64 exec, s[28:29]
  v_swap_b32 v232, v234
  v_swap_b32 v233, v235
  v_swap_b32 v236, v238
  v_swap_b32 v237, v239
  v_swap_b32 v240, v242
  v_swap_b32 v241, v243
  s_mov_b64 exec, -1
  v_mfma_f32_16x16x32_bf16 v[124:127], a[224:227], v[160:163], v[124:127]
  v_bfe_u32 v40, v1, 2, 3
  v_lshrrev_b32 v41, 5, v1
  v_mfma_f32_16x16x32_bf16 v[80:83], a[216:219], v[164:167], v[80:83]
  v_lshl_add_u32 v40, v41, 4, v40
  v_mul_u32_u24 v40, 224, v40
  v_mfma_f32_16x16x32_bf16 v[104:107], a[220:223], v[164:167], v[104:107]
  v_and_b32 v41, 3, v1
  v_lshl_add_u32 v2, v41, 3, v40
  v_mfma_f32_16x16x32_bf16 v[128:131], a[224:227], v[164:167], v[128:131]
  v_add_u32 v3, 57344, v2
  s_mul_i32 s31, s22, 4608
  v_mfma_f32_16x16x32_bf16 v[84:87], a[216:219], v[168:171], v[84:87]
  v_subrev_u32 v4, s31, v37
  v_subrev_u32 v5, s31, v38
  v_mfma_f32_16x16x32_bf16 v[108:111], a[220:223], v[168:171], v[108:111]
  s_lshl_b32 s31, s21, 9
  s_lshl_b32 s32, s26, 4
  v_mfma_f32_16x16x32_bf16 v[132:135], a[224:227], v[168:171], v[132:135]
  s_add_u32 s31, s31, s32
  s_lshl_b32 s32, s20, 2
  v_mfma_f32_16x16x32_bf16 v[76:79], a[228:231], v[184:187], v[76:79]
  s_add_u32 s31, s31, s32
  s_lshl_b32 s31, s31, 7
  v_mfma_f32_16x16x32_bf16 v[100:103], a[232:235], v[184:187], v[100:103]
  s_add_u32 s31, s31, 41943040
  v_lshlrev_b32 v41, 7, v41
  v_mfma_f32_16x16x32_bf16 v[124:127], a[236:239], v[184:187], v[124:127]
  v_add_u32 v7, s31, v41
  s_lshl_b32 s31, s21, 3
  s_add_u32 s31, s31, s23
  v_mfma_f32_16x16x32_bf16 v[80:83], a[228:231], v[188:191], v[80:83]
  s_lshl_b32 s31, s31, 2
  s_add_u32 s31, s31, s22
  s_lshl_b32 s31, s31, 2
  s_add_u32 s31, s31, s25
  s_lshl_b32 s32, s31, 9
  s_add_u32 s32, s32, 42991616
  v_add_u32 v8, s32, v41
  s_mul_i32 s31, s31, 49152
  s_add_u32 s31, s31, 8388608
  s_mul_i32 s32, s20, 3072
  s_add_u32 s32, s32, s31
  v_lshrrev_b32 v40, 4, v1
  s_waitcnt vmcnt(10)
  ds_read_b128 a[180:183], v26 offset:6144
  ds_read_b128 a[184:187], v27 offset:6144
  v_mfma_f32_16x16x32_bf16 v[104:107], a[232:235], v[188:191], v[104:107]
  v_bfe_u32 v45, v1, 2, 2
  v_and_b32 v46, 3, v1
  v_mfma_f32_16x16x32_bf16 v[128:131], a[236:239], v[188:191], v[128:131]
  v_cmp_eq_u32 vcc, s20, v45
  v_mul_u32_u24 v43, 12288, v45
  v_mfma_f32_16x16x32_bf16 v[84:87], a[228:231], v[192:195], v[84:87]
  v_lshl_add_u32 v42, v40, 2, v46
  v_lshl_add_u32 v43, v42, 4, v43
  v_mfma_f32_16x16x32_bf16 v[108:111], a[232:235], v[192:195], v[108:111]
  v_add_u32 v6, s32, v43
  v_mov_b32 v41, 0x7ff00000
  v_mfma_f32_16x16x32_bf16 v[132:135], a[236:239], v[192:195], v[132:135]
  v_cndmask_b32 v6, v6, v41, vcc
  s_mul_i32 s32, s20, 12288
  v_mfma_f32_16x16x32_bf16 v[76:79], a[240:243], v[208:211], v[76:79]
  s_add_u32 s32, s32, s31
  v_lshlrev_b32 v43, 4, v1
  v_mfma_f32_16x16x32_bf16 v[100:103], a[244:247], v[208:211], v[100:103]
  s_waitcnt lgkmcnt(0)
  s_add_u32 m0, s33, 6144
  s_mul_i32 s90, s81, 24576
  s_add_u32 s90, s90, s86
  s_add_u32 s35, s90, 0
  buffer_load_dwordx4 v28, s[64:67], s35 offen nt lds
  buffer_load_dwordx4 v29, s[64:67], s35 offen offset:1024 nt lds
  v_mfma_f32_16x16x32_bf16 v[124:127], a[248:251], v[208:211], v[124:127]
  v_add_u32 v9, s32, v43
  v_add_u32 v16, s33, v43
  s_lshl_b32 s32, s20, 6
  v_mfma_f32_16x16x32_bf16 v[80:83], a[240:243], v[212:215], v[80:83]
  s_add_u32 s32, s32, s33
  v_lshlrev_b32 v43, 10, v40
  v_lshl_add_u32 v43, v45, 8, v43
  v_mfma_f32_16x16x32_bf16 v[104:107], a[244:247], v[212:215], v[104:107]
  v_lshl_add_u32 v43, v46, 4, v43
  v_add_u32 v17, s32, v43
  s_mul_i32 s31, s26, 86016
  s_mul_i32 s32, s21, 896
  s_add_u32 s31, s31, s32
  s_mul_i32 s32, s22, 224
  s_add_u32 s31, s31, s32
  s_mul_i32 s32, s20, 7168
  s_add_u32 s31, s31, s32
  v_mul_u32_u24 v42, 1792, v46
  v_lshl_add_u32 v42, v45, 3, v42
  v_add_u32 v42, s31, v42
  s_waitcnt vmcnt(10)
  ds_read_b128 a[188:191], v26 offset:8192
  ds_read_b128 a[192:195], v27 offset:8192
  v_mfma_f32_16x16x32_bf16 v[128:131], a[248:251], v[212:215], v[128:131]
  v_lshl_add_u32 v44, v40, 1, 0
  v_mul_u32_u24 v41, 43, v44
  v_mfma_f32_16x16x32_bf16 v[84:87], a[240:243], v[216:219], v[84:87]
  v_lshrrev_b32 v41, 7, v41
  v_mul_u32_u24 v43, 3, v41
  v_mfma_f32_16x16x32_bf16 v[108:111], a[244:247], v[216:219], v[108:111]
  v_sub_u32 v43, v44, v43
  v_mul_u32_u24 v43, 28672, v43
  v_mfma_f32_16x16x32_bf16 v[132:135], a[248:251], v[216:219], v[132:135]
  v_lshl_add_u32 v43, v41, 5, v43
  v_add_u32 v10, v42, v43
  v_mfma_f32_16x16x32_bf16 v[76:79], a[252:255], v[232:235], v[76:79]
  v_lshl_add_u32 v44, v40, 1, 1
  v_mul_u32_u24 v41, 43, v44
  v_mfma_f32_16x16x32_bf16 v[100:103], a[0:3], v[232:235], v[100:103]
  v_lshrrev_b32 v41, 7, v41
  v_mul_u32_u24 v43, 3, v41
  v_mfma_f32_16x16x32_bf16 v[124:127], a[4:7], v[232:235], v[124:127]
  s_waitcnt lgkmcnt(0)
  s_add_u32 m0, s33, 8192
  s_add_u32 s35, s90, 8192
  buffer_load_dwordx4 v28, s[64:67], s35 offen nt lds
  buffer_load_dwordx4 v29, s[64:67], s35 offen offset:1024 nt lds
  v_mfma_f32_16x16x32_bf16 v[80:83], a[252:255], v[236:239], v[80:83]
  v_sub_u32 v43, v44, v43
  v_mul_u32_u24 v43, 28672, v43
  v_lshl_add_u32 v43, v41, 5, v43
  v_mfma_f32_16x16x32_bf16 v[104:107], a[0:3], v[236:239], v[104:107]
  v_add_u32 v11, v42, v43
  v_lshl_add_u32 v44, v40, 1, 8
  v_mul_u32_u24 v41, 43, v44
  v_mfma_f32_16x16x32_bf16 v[128:131], a[4:7], v[236:239], v[128:131]
  v_lshrrev_b32 v41, 7, v41
  v_mul_u32_u24 v43, 3, v41
  v_sub_u32 v43, v44, v43
  v_mul_u32_u24 v43, 28672, v43
  v_lshl_add_u32 v43, v41, 5, v43
  v_add_u32 v12, v42, v43
  v_lshl_add_u32 v44, v40, 1, 9
  v_mul_u32_u24 v41, 43, v44
  v_lshrrev_b32 v41, 7, v41
  v_mul_u32_u24 v43, 3, v41
  v_sub_u32 v43, v44, v43
  v_mul_u32_u24 v43, 28672, v43
  s_waitcnt vmcnt(10)
  ds_read_b128 a[196:199], v26 offset:10240
  ds_read_b128 a[200:203], v27 offset:10240
  v_mfma_f32_16x16x32_bf16 v[84:87], a[252:255], v[240:243], v[84:87]
  v_lshl_add_u32 v43, v41, 5, v43
  v_add_u32 v13, v42, v43
  v_mfma_f32_16x16x32_bf16 v[108:111], a[0:3], v[240:243], v[108:111]
  v_lshl_add_u32 v44, v40, 1, 16
  v_mul_u32_u24 v41, 43, v44
  v_mfma_f32_16x16x32_bf16 v[132:135], a[4:7], v[240:243], v[132:135]
  v_lshrrev_b32 v41, 7, v41
  v_mul_u32_u24 v43, 3, v41
  v_sub_u32 v43, v44, v43
  v_mul_u32_u24 v43, 28672, v43
  v_lshl_add_u32 v43, v41, 5, v43
  v_add_u32 v14, v42, v43
  v_cmp_lt_u32 vcc, 20, v44
  v_mov_b32 v41, 0x7ff00000
  s_waitcnt lgkmcnt(0)
  s_add_u32 m0, s33, 10240
  s_add_u32 s35, s90, 16384
  buffer_load_dwordx4 v28, s[64:67], s35 offen nt lds
  buffer_load_dwordx4 v29, s[64:67], s35 offen offset:1024 nt lds
  v_cndmask_b32 v14, v14, v41, vcc
  v_lshl_add_u32 v44, v40, 1, 17
  v_mul_u32_u24 v41, 43, v44
  v_lshrrev_b32 v41, 7, v41
  v_mul_u32_u24 v43, 3, v41
  v_sub_u32 v43, v44, v43
  v_mul_u32_u24 v43, 28672, v43
  v_lshl_add_u32 v43, v41, 5, v43
  v_add_u32 v15, v42, v43
  v_cmp_lt_u32 vcc, 20, v44
  v_mov_b32 v41, 0x7ff00000
  s_nop 0
  v_cndmask_b32 v15, v15, v41, vcc
  v_cmp_eq_u32 vcc, 0, v39
  s_nop 1
  s_cmp_eq_u64 vcc, 0
  s_cbranch_scc0 Ltag
Ltag_r:
  v_readfirstlane_b32 s57, v39
  v_max3_f32 v148, v76, v77, v78
  v_max3_f32 v149, v80, v81, v82
  v_max3_f32 v150, v84, v85, v86
  v_max3_f32 v148, v148, v79, v100
  v_max3_f32 v149, v149, v83, v104
  v_max3_f32 v150, v150, v87, v108
  v_max3_f32 v148, v148, v101, v102
  v_max3_f32 v149, v149, v105, v106
  v_max3_f32 v150, v150, v109, v110
  v_max3_f32 v148, v148, v103, v124
  v_max3_f32 v149, v149, v107, v128
  v_max3_f32 v150, v150, v111, v132
  v_max3_f32 v148, v148, v125, v126
  v_max3_f32 v149, v149, v129, v130
  v_max3_f32 v150, v150, v133, v134
  v_max_f32 v148, v148, v127
  s_waitcnt vmcnt(10)
  ds_read_b128 a[204:207], v26 offset:0
  ds_read_b128 a[208:211], v27 offset:0
  v_max_f32 v149, v149, v131
  v_max_f32 v150, v150, v135
  v_mov_b32 v151, v148
  v_mov_b32 v152, v149
  v_mov_b32 v153, v150
  v_permlane32_swap_b32 v148, v151
  v_permlane32_swap_b32 v149, v152
  v_permlane32_swap_b32 v150, v153
  v_max_f32 v148, v148, v151
  v_max_f32 v149, v149, v152
  v_max_f32 v150, v150, v153
  v_mov_b32 v151, v148
  v_mov_b32 v152, v149
  v_mov_b32 v153, v150
  v_permlane16_swap_b32 v148, v151
  v_permlane16_swap_b32 v149, v152
  s_add_u32 m0, s34, 57344
  s_mul_i32 s91, s81, 229376
  s_add_u32 s91, s91, s88
  buffer_load_dwordx4 v30, s[68:71], s91 offen offset:0 lds
  v_permlane16_swap_b32 v150, v153
  v_max_f32 v148, v148, v151
  v_max_f32 v149, v149, v152
  v_max_f32 v150, v150, v153
  v_mul_f32 v148, s30, v148
  v_mul_f32 v149, s30, v149
  v_mul_f32 v150, s30, v150
  v_fma_f32 v76, v76, s30, -v148
  v_fma_f32 v80, v80, s30, -v149
  v_fma_f32 v84, v84, s30, -v150
  v_exp_f32 v76, v76
  v_exp_f32 v80, v80
  v_exp_f32 v84, v84
  v_fma_f32 v77, v77, s30, -v148
  v_fma_f32 v81, v81, s30, -v149
  v_fma_f32 v85, v85, s30, -v150
  buffer_load_dwordx4 v31, s[68:71], s91 offen offset:1024 lds
  v_exp_f32 v77, v77
  v_exp_f32 v81, v81
  v_exp_f32 v85, v85
  v_fma_f32 v78, v78, s30, -v148
  v_fma_f32 v82, v82, s30, -v149
  v_fma_f32 v86, v86, s30, -v150
  v_exp_f32 v78, v78
  v_exp_f32 v82, v82
  s_waitcnt vmcnt(10)
  ds_read_b128 a[212:215], v26 offset:2048
  ds_read_b128 a[216:219], v27 offset:2048
  v_exp_f32 v86, v86
  v_fma_f32 v79, v79, s30, -v148
  v_fma_f32 v83, v83, s30, -v149
  v_fma_f32 v87, v87, s30, -v150
  v_exp_f32 v79, v79
  v_exp_f32 v83, v83
  v_exp_f32 v87, v87
  v_fma_f32 v100, v100, s30, -v148
  buffer_load_dwordx4 v32, s[68:71], s91 offen offset:2048 lds
  v_fma_f32 v104, v104, s30, -v149
  v_fma_f32 v108, v108, s30, -v150
  v_exp_f32 v100, v100
  v_exp_f32 v104, v104
  v_exp_f32 v108, v108
  v_fma_f32 v101, v101, s30, -v148
  v_fma_f32 v105, v105, s30, -v149
  v_fma_f32 v109, v109, s30, -v150
  v_exp_f32 v101, v101
  v_exp_f32 v105, v105
  v_exp_f32 v109, v109
  v_fma_f32 v102, v102, s30, -v148
  v_fma_f32 v106, v106, s30, -v149
  v_fma_f32 v110, v110, s30, -v150
  v_exp_f32 v102, v102
  v_exp_f32 v106, v106
  buffer_load_dwordx4 v33, s[68:71], s91 offen offset:3072 lds
  v_exp_f32 v110, v110
  v_fma_f32 v103, v103, s30, -v148
  v_fma_f32 v107, v107, s30, -v149
  v_fma_f32 v111, v111, s30, -v150
  v_exp_f32 v103, v103
  v_exp_f32 v107, v107
  v_exp_f32 v111, v111
  v_fma_f32 v124, v124, s30, -v148
  v_fma_f32 v128, v128, s30, -v149
  v_fma_f32 v132, v132, s30, -v150
  v_exp_f32 v124, v124
  v_exp_f32 v128, v128
  v_exp_f32 v132, v132
  v_fma_f32 v125, v125, s30, -v148
  v_fma_f32 v129, v129, s30, -v149
  v_fma_f32 v133, v133, s30, -v150
  s_waitcnt vmcnt(10)
  ds_read_b128 a[220:223], v26 offset:4096
  ds_read_b128 a[224:227], v27 offset:4096
  s_add_u32 m0, s34, 61440
  s_nop 0
  buffer_load_dwordx4 v34, s[68:71], s91 offen offset:0 lds
  v_exp_f32 v125, v125
  v_exp_f32 v129, v129
  v_exp_f32 v133, v133
  v_fma_f32 v126, v126, s30, -v148
  v_fma_f32 v130, v130, s30, -v149
  v_fma_f32 v134, v134, s30, -v150
  v_exp_f32 v126, v126
  v_exp_f32 v130, v130
  v_exp_f32 v134, v134
  v_fma_f32 v127, v127, s30, -v148
  v_fma_f32 v131, v131, s30, -v149
  v_fma_f32 v135, v135, s30, -v150
  v_exp_f32 v127, v127
  v_exp_f32 v131, v131
  v_exp_f32 v135, v135
  v_add_f32 v148, v76, v77
  buffer_load_dwordx4 v35, s[68:71], s91 offen offset:1024 lds
  v_add_f32 v149, v80, v81
  v_add_f32 v150, v84, v85
  v_add_f32 v148, v148, v78
  v_add_f32 v149, v149, v82
  v_add_f32 v150, v150, v86
  v_add_f32 v148, v148, v79
  v_add_f32 v149, v149, v83
  v_add_f32 v150, v150, v87
  s_barrier
  ds_read_b64_tr_b16 v[40:41], v2 offset:0
  ds_read_b64_tr_b16 v[42:43], v2 offset:1792
  ds_read_b64_tr_b16 v[44:45], v2 offset:32
  ds_read_b64_tr_b16 v[46:47], v2 offset:1824
  ds_read_b64_tr_b16 v[48:49], v2 offset:64
  ds_read_b64_tr_b16 v[50:51], v2 offset:1856
  ds_read_b64_tr_b16 v[52:53], v2 offset:96
  ds_read_b64_tr_b16 v[54:55], v2 offset:1888
  s_waitcnt lgkmcnt(6)
  v_mfma_f32_16x16x32_bf16 v[172:175], a[8:11], v[40:43], 0
  ds_read_b64_tr_b16 v[56:57], v2 offset:128
  v_add_f32 v148, v148, v100
  v_mfma_f32_16x16x32_bf16 v[176:179], a[16:19], v[40:43], 0
  ds_read_b64_tr_b16 v[58:59], v2 offset:1920
  v_add_f32 v149, v149, v104
  v_mfma_f32_16x16x32_bf16 v[180:183], a[24:27], v[40:43], 0
  v_add_f32 v150, v150, v108
  v_add_f32 v148, v148, v101
  s_waitcnt lgkmcnt(6)
  v_mfma_f32_16x16x32_bf16 v[184:187], a[8:11], v[44:47], 0
  ds_read_b64_tr_b16 v[60:61], v2 offset:160
  buffer_load_dwordx4 v36, s[68:71], s91 offen offset:2048 lds
  v_mfma_f32_16x16x32_bf16 v[188:191], a[16:19], v[44:47], 0
  ds_read_b64_tr_b16 v[62:63], v2 offset:1952
  v_add_f32 v149, v149, v105
  v_mfma_f32_16x16x32_bf16 v[192:195], a[24:27], v[44:47], 0
  s_waitcnt lgkmcnt(4)
  v_add_f32 v150, v150, v109
  v_mfma_f32_16x16x32_bf16 v[196:199], a[8:11], v[48:51], 0
  ds_read_b64_tr_b16 v[40:41], v2 offset:192
  v_add_f32 v148, v148, v102
  v_mfma_f32_16x16x32_bf16 v[200:203], a[16:19], v[48:51], 0
  ds_read_b64_tr_b16 v[42:43], v2 offset:1984
  v_add_f32 v149, v149, v106
  v_mfma_f32_16x16x32_bf16 v[204:207], a[24:27], v[48:51], 0
  v_add_f32 v150, v150, v110
  v_add_f32 v148, v148, v103
  v_mfma_f32_16x16x32_bf16 v[208:211], a[8:11], v[52:55], 0
  ds_read_b64_tr_b16 v[44:45], v2 offset:7168
  v_add_f32 v149, v149, v107
  v_mfma_f32_16x16x32_bf16 v[212:215], a[16:19], v[52:55], 0
  ds_read_b64_tr_b16 v[46:47], v2 offset:8960
  v_add_f32 v150, v150, v111
  v_mfma_f32_16x16x32_bf16 v[216:219], a[24:27], v[52:55], 0
  s_waitcnt lgkmcnt(4)
  s_add_u32 m0, s34, 86016
  s_mul_i32 s91, s81, 229376
  s_add_u32 s91, s91, s89
  buffer_load_dwordx4 v30, s[68:71], s91 offen offset:0 lds
  v_mfma_f32_16x16x32_bf16 v[220:223], a[8:11], v[56:59], 0
  ds_read_b64_tr_b16 v[48:49], v2 offset:7200
  v_add_f32 v148, v148, v124
  v_add_f32 v149, v149, v128
  v_mfma_f32_16x16x32_bf16 v[224:227], a[16:19], v[56:59], 0
  ds_read_b64_tr_b16 v[50:51], v2 offset:8992
  v_add_f32 v150, v150, v132
  v_add_f32 v148, v148, v125
  v_mfma_f32_16x16x32_bf16 v[228:231], a[24:27], v[56:59], 0
  v_add_f32 v149, v149, v129
  v_add_f32 v150, v150, v133
  v_mfma_f32_16x16x32_bf16 v[232:235], a[8:11], v[60:63], 0
  ds_read_b64_tr_b16 v[52:53], v2 offset:7232
  v_add_f32 v148, v148, v126
  v_add_f32 v149, v149, v130
  buffer_load_dwordx4 v31, s[68:71], s91 offen offset:1024 lds
  v_add_f32 v150, v150, v134
  v_add_f32 v148, v148, v127
  v_add_f32 v149, v149, v131
  v_add_f32 v150, v150, v135
  v_mov_b32 v151, v148
  v_mov_b32 v152, v149
  s_waitcnt vmcnt(13)
  ds_read_b128 a[228:231], v26 offset:6144
  ds_read_b128 a[232:235], v27 offset:6144
  v_mfma_f32_16x16x32_bf16 v[236:239], a[16:19], v[60:63], 0
  ds_read_b64_tr_b16 v[54:55], v2 offset:9024
  v_mov_b32 v153, v150
  v_mfma_f32_16x16x32_bf16 v[240:243], a[24:27], v[60:63], 0
  s_waitcnt lgkmcnt(6)
  v_permlane32_swap_b32 v148, v151
  v_mfma_f32_16x16x32_bf16 v[244:247], a[8:11], v[40:43], 0
  ds_read_b64_tr_b16 v[56:57], v2 offset:7264
  buffer_load_dwordx4 v32, s[68:71], s91 offen offset:2048 lds
  v_mfma_f32_16x16x32_bf16 v[248:251], a[16:19], v[40:43], 0
  ds_read_b64_tr_b16 v[58:59], v2 offset:9056
  v_permlane32_swap_b32 v149, v152
  v_mfma_f32_16x16x32_bf16 v[252:255], a[24:27], v[40:43], 0
  v_permlane32_swap_b32 v150, v153
  v_add_f32 v148, v148, v151
  v_mfma_f32_16x16x32_bf16 v[172:175], a[12:15], v[44:47], v[172:175]
  ds_read_b64_tr_b16 v[60:61], v2 offset:7296
  v_add_f32 v149, v149, v152
  v_mfma_f32_16x16x32_bf16 v[176:179], a[20:23], v[44:47], v[176:179]
  ds_read_b64_tr_b16 v[62:63], v2 offset:9088
  v_add_f32 v150, v150, v153
  v_mov_b32 v151, v148
  v_mfma_f32_16x16x32_bf16 v[180:183], a[28:31], v[44:47], v[180:183]
  s_waitcnt lgkmcnt(4)
  v_mov_b32 v152, v149
  v_mov_b32 v153, v150
  buffer_load_dwordx4 v33, s[68:71], s91 offen offset:3072 lds
  v_mfma_f32_16x16x32_bf16 v[184:187], a[12:15], v[48:51], v[184:187]
  ds_read_b64_tr_b16 v[40:41], v2 offset:7328
  v_permlane16_swap_b32 v148, v151
  v_permlane16_swap_b32 v149, v152
  v_mfma_f32_16x16x32_bf16 v[188:191], a[20:23], v[48:51], v[188:191]
  ds_read_b64_tr_b16 v[42:43], v2 offset:9120
  v_permlane16_swap_b32 v150, v153
  v_add_f32 v148, v148, v151
  v_add_f32 v149, v149, v152
  v_add_f32 v150, v150, v153
  v_rcp_f32 v148, v148
  v_rcp_f32 v149, v149
  s_add_u32 m0, s34, 90112
  s_nop 0
  buffer_load_dwordx4 v34, s[68:71], s91 offen offset:0 lds
  v_rcp_f32 v150, v150
  v_mul_f32 v76, v76, v148
  s_waitcnt vmcnt(14)
  ds_read_b128 a[236:239], v26 offset:8192
  ds_read_b128 a[240:243], v27 offset:8192
  v_mfma_f32_16x16x32_bf16 v[192:195], a[28:31], v[48:51], v[192:195]
  v_mul_f32 v77, v77, v148
  v_mul_f32 v78, v78, v148
  v_mfma_f32_16x16x32_bf16 v[196:199], a[12:15], v[52:55], v[196:199]
  ds_read_b64_tr_b16 v[44:45], v2 offset:7360
  v_mul_f32 v79, v79, v148
  v_mfma_f32_16x16x32_bf16 v[200:203], a[20:23], v[52:55], v[200:203]
  ds_read_b64_tr_b16 v[46:47], v2 offset:9152
  v_mul_f32 v100, v100, v148
  v_mfma_f32_16x16x32_bf16 v[204:207], a[28:31], v[52:55], v[204:207]
  s_waitcnt lgkmcnt(6)
  v_mul_f32 v101, v101, v148
  v_mfma_f32_16x16x32_bf16 v[208:211], a[12:15], v[56:59], v[208:211]
  ds_read_b64_tr_b16 v[48:49], v2 offset:14336
  v_mul_f32 v102, v102, v148
  v_mfma_f32_16x16x32_bf16 v[212:215], a[20:23], v[56:59], v[212:215]
  ds_read_b64_tr_b16 v[50:51], v2 offset:16128
  buffer_load_dwordx4 v35, s[68:71], s91 offen offset:1024 lds
  v_mfma_f32_16x16x32_bf16 v[216:219], a[28:31], v[56:59], v[216:219]
  v_mul_f32 v103, v103, v148
  v_mul_f32 v124, v124, v148
  v_mfma_f32_16x16x32_bf16 v[220:223], a[12:15], v[60:63], v[220:223]
  ds_read_b64_tr_b16 v[52:53], v2 offset:14368
  v_mul_f32 v125, v125, v148
  v_mul_f32 v126, v126, v148
  v_mfma_f32_16x16x32_bf16 v[224:227], a[20:23], v[60:63], v[224:227]
  ds_read_b64_tr_b16 v[54:55], v2 offset:16160
  v_mul_f32 v127, v127, v148
  v_cvt_pk_bf16_f32 v154, v76, v77
  v_mfma_f32_16x16x32_bf16 v[228:231], a[28:31], v[60:63], v[228:231]
  s_waitcnt lgkmcnt(4)
  v_cvt_pk_bf16_f32 v155, v78, v79
  v_cvt_pk_bf16_f32 v156, v100, v101
  buffer_load_dwordx4 v36, s[68:71], s91 offen offset:2048 lds
  v_cvt_pk_bf16_f32 v157, v102, v103
  v_cvt_pk_bf16_f32 v158, v124, v125
  v_cvt_pk_bf16_f32 v159, v126, v127
  buffer_store_dwordx4 v[154:157], v37, s[16:19], 0 offen offset:0 sc1
  buffer_store_dwordx2 v[158:159], v38, s[16:19], 0 offen offset:0 sc1
  v_mul_f32 v80, v80, v149
  s_waitcnt vmcnt(16)
  ds_read_b128 a[244:247], v26 offset:10240
  ds_read_b128 a[248:251], v27 offset:10240
  v_mfma_f32_16x16x32_bf16 v[232:235], a[12:15], v[40:43], v[232:235]
  ds_read_b64_tr_b16 v[56:57], v2 offset:14400
  v_mul_f32 v81, v81, v149
  v_mfma_f32_16x16x32_bf16 v[236:239], a[20:23], v[40:43], v[236:239]
  ds_read_b64_tr_b16 v[58:59], v2 offset:16192
  v_mul_f32 v82, v82, v149
  v_mfma_f32_16x16x32_bf16 v[240:243], a[28:31], v[40:43], v[240:243]
  s_add_u32 m0, s33, 0
  v_mfma_f32_16x16x32_bf16 v[244:247], a[12:15], v[44:47], v[244:247]
  ds_read_b64_tr_b16 v[60:61], v2 offset:14432
  s_mul_i32 s90, s81, 24576
  s_add_u32 s90, s90, s87
  s_add_u32 s35, s90, 0
  buffer_load_dwordx4 v28, s[64:67], s35 offen nt lds
  buffer_load_dwordx4 v29, s[64:67], s35 offen offset:1024 nt lds
  v_mfma_f32_16x16x32_bf16 v[248:251], a[20:23], v[44:47], v[248:251]
  ds_read_b64_tr_b16 v[62:63], v2 offset:16224
  v_mul_f32 v83, v83, v149
  v_mul_f32 v104, v104, v149
  v_mfma_f32_16x16x32_bf16 v[252:255], a[28:31], v[44:47], v[252:255]
  s_waitcnt lgkmcnt(6)
  v_mul_f32 v105, v105, v149
  v_mul_f32 v106, v106, v149
  v_mfma_f32_16x16x32_bf16 v[172:175], a[32:35], v[48:51], v[172:175]
  ds_read_b64_tr_b16 v[40:41], v2 offset:14464
  v_mul_f32 v107, v107, v149
  v_mul_f32 v128, v128, v149
  v_mfma_f32_16x16x32_bf16 v[176:179], a[40:43], v[48:51], v[176:179]
  ds_read_b64_tr_b16 v[42:43], v2 offset:16256
  v_mul_f32 v129, v129, v149
  v_mul_f32 v130, v130, v149
  v_mfma_f32_16x16x32_bf16 v[180:183], a[48:51], v[48:51], v[180:183]
  v_mul_f32 v131, v131, v149
  v_cvt_pk_bf16_f32 v160, v80, v81
  v_mfma_f32_16x16x32_bf16 v[184:187], a[32:35], v[52:55], v[184:187]
  ds_read_b64_tr_b16 v[44:45], v2 offset:14496
  v_cvt_pk_bf16_f32 v161, v82, v83
  v_cvt_pk_bf16_f32 v162, v104, v105
  v_mfma_f32_16x16x32_bf16 v[188:191], a[40:43], v[52:55], v[188:191]
  ds_read_b64_tr_b16 v[46:47], v2 offset:16288
  v_cvt_pk_bf16_f32 v163, v106, v107
  v_cvt_pk_bf16_f32 v164, v128, v129
  v_mfma_f32_16x16x32_bf16 v[192:195], a[48:51], v[52:55], v[192:195]
  s_waitcnt lgkmcnt(4)
  v_cvt_pk_bf16_f32 v165, v130, v131
  buffer_store_dwordx4 v[160:163], v37, s[16:19], 0 offen offset:1536 sc1
  v_mfma_f32_16x16x32_bf16 v[196:199], a[32:35], v[56:59], v[196:199]
  ds_read_b64_tr_b16 v[48:49], v2 offset:14528
  buffer_store_dwordx2 v[164:165], v38, s[16:19], 0 offen offset:1536 sc1
  v_mul_f32 v84, v84, v150
  v_mfma_f32_16x16x32_bf16 v[200:203], a[40:43], v[56:59], v[200:203]
  ds_read_b64_tr_b16 v[50:51], v2 offset:16320
  v_mul_f32 v85, v85, v150
  v_mul_f32 v86, v86, v150
  s_add_u32 m0, s33, 2048
  s_add_u32 s35, s90, 8192
  buffer_load_dwordx4 v28, s[64:67], s35 offen nt lds
  buffer_load_dwordx4 v29, s[64:67], s35 offen offset:1024 nt lds
  v_mfma_f32_16x16x32_bf16 v[204:207], a[48:51], v[56:59], v[204:207]
  v_mul_f32 v87, v87, v150
  v_mul_f32 v108, v108, v150
  v_mfma_f32_16x16x32_bf16 v[208:211], a[32:35], v[60:63], v[208:211]
  ds_read_b64_tr_b16 v[52:53], v2 offset:21504
  v_mul_f32 v109, v109, v150
  v_mul_f32 v110, v110, v150
  v_mfma_f32_16x16x32_bf16 v[212:215], a[40:43], v[60:63], v[212:215]
  ds_read_b64_tr_b16 v[54:55], v2 offset:23296
  v_mul_f32 v111, v111, v150
  v_mul_f32 v132, v132, v150
  v_mfma_f32_16x16x32_bf16 v[216:219], a[48:51], v[60:63], v[216:219]
  s_waitcnt lgkmcnt(4)
  v_mul_f32 v133, v133, v150
  v_mul_f32 v134, v134, v150
  v_mfma_f32_16x16x32_bf16 v[220:223], a[32:35], v[40:43], v[220:223]
  ds_read_b64_tr_b16 v[56:57], v2 offset:21536
  v_mul_f32 v135, v135, v150
  v_cvt_pk_bf16_f32 v166, v84, v85
  v_mfma_f32_16x16x32_bf16 v[224:227], a[40:43], v[40:43], v[224:227]
  ds_read_b64_tr_b16 v[58:59], v2 offset:23328
  v_cvt_pk_bf16_f32 v167, v86, v87
  v_cvt_pk_bf16_f32 v168, v108, v109
  v_mfma_f32_16x16x32_bf16 v[228:231], a[48:51], v[40:43], v[228:231]
  v_cvt_pk_bf16_f32 v169, v110, v111
  v_cvt_pk_bf16_f32 v170, v132, v133
  v_mfma_f32_16x16x32_bf16 v[232:235], a[32:35], v[44:47], v[232:235]
  ds_read_b64_tr_b16 v[60:61], v2 offset:21568
  v_cvt_pk_bf16_f32 v171, v134, v135
  buffer_store_dwordx4 v[166:169], v37, s[16:19], 0 offen offset:3072 sc1
  v_mfma_f32_16x16x32_bf16 v[236:239], a[40:43], v[44:47], v[236:239]
  ds_read_b64_tr_b16 v[62:63], v2 offset:23360
  buffer_store_dwordx2 v[170:171], v38, s[16:19], 0 offen offset:3072 sc1
  v_mfma_f32_16x16x32_bf16 v[240:243], a[48:51], v[44:47], v[240:243]
  s_waitcnt lgkmcnt(4)
  s_add_u32 m0, s33, 4096
  s_add_u32 s35, s90, 16384
  buffer_load_dwordx4 v28, s[64:67], s35 offen nt lds
  buffer_load_dwordx4 v29, s[64:67], s35 offen offset:1024 nt lds
  v_mfma_f32_16x16x32_bf16 v[244:247], a[32:35], v[48:51], v[244:247]
  ds_read_b64_tr_b16 v[40:41], v2 offset:21600
  v_mfma_f32_16x16x32_bf16 v[248:251], a[40:43], v[48:51], v[248:251]
  ds_read_b64_tr_b16 v[42:43], v2 offset:23392
  v_mfma_f32_16x16x32_bf16 v[252:255], a[48:51], v[48:51], v[252:255]
  v_mfma_f32_16x16x32_bf16 v[172:175], a[36:39], v[52:55], v[172:175]
  ds_read_b64_tr_b16 v[44:45], v2 offset:21632
  v_mfma_f32_16x16x32_bf16 v[176:179], a[44:47], v[52:55], v[176:179]
  ds_read_b64_tr_b16 v[46:47], v2 offset:23424
  s_add_u32 m0, s33, 6144
  v_mfma_f32_16x16x32_bf16 v[180:183], a[52:55], v[52:55], v[180:183]
  s_waitcnt lgkmcnt(4)
  s_mul_i32 s90, s82, 24576
  v_mfma_f32_16x16x32_bf16 v[184:187], a[36:39], v[56:59], v[184:187]
  ds_read_b64_tr_b16 v[48:49], v2 offset:21664
  s_add_u32 s90, s90, s84
  v_mfma_f32_16x16x32_bf16 v[188:191], a[44:47], v[56:59], v[188:191]
  ds_read_b64_tr_b16 v[50:51], v2 offset:23456
  s_add_u32 s35, s90, 0
  v_mfma_f32_16x16x32_bf16 v[192:195], a[52:55], v[56:59], v[192:195]
  buffer_load_dwordx4 v28, s[64:67], s35 offen nt lds
  buffer_load_dwordx4 v29, s[64:67], s35 offen offset:1024 nt lds
  v_mfma_f32_16x16x32_bf16 v[196:199], a[36:39], v[60:63], v[196:199]
  ds_read_b64_tr_b16 v[52:53], v2 offset:21696
  v_mfma_f32_16x16x32_bf16 v[200:203], a[44:47], v[60:63], v[200:203]
  ds_read_b64_tr_b16 v[54:55], v2 offset:23488
  v_mfma_f32_16x16x32_bf16 v[204:207], a[52:55], v[60:63], v[204:207]
  s_waitcnt lgkmcnt(4)
  v_mfma_f32_16x16x32_bf16 v[208:211], a[36:39], v[40:43], v[208:211]
  ds_read_b64_tr_b16 v[56:57], v2 offset:28672
  v_mfma_f32_16x16x32_bf16 v[212:215], a[44:47], v[40:43], v[212:215]
  ds_read_b64_tr_b16 v[58:59], v2 offset:30464
  v_mfma_f32_16x16x32_bf16 v[216:219], a[52:55], v[40:43], v[216:219]
  s_add_u32 m0, s33, 8192
  s_add_u32 s35, s90, 8192
  v_mfma_f32_16x16x32_bf16 v[220:223], a[36:39], v[44:47], v[220:223]
  ds_read_b64_tr_b16 v[60:61], v2 offset:28704
  buffer_load_dwordx4 v28, s[64:67], s35 offen nt lds
  v_mfma_f32_16x16x32_bf16 v[224:227], a[44:47], v[44:47], v[224:227]
  ds_read_b64_tr_b16 v[62:63], v2 offset:30496
  buffer_load_dwordx4 v29, s[64:67], s35 offen offset:1024 nt lds
  v_mfma_f32_16x16x32_bf16 v[228:231], a[52:55], v[44:47], v[228:231]
  s_waitcnt lgkmcnt(4)
  v_mfma_f32_16x16x32_bf16 v[232:235], a[36:39], v[48:51], v[232:235]
  ds_read_b64_tr_b16 v[40:41], v2 offset:28736
  v_mfma_f32_16x16x32_bf16 v[236:239], a[44:47], v[48:51], v[236:239]
  ds_read_b64_tr_b16 v[42:43], v2 offset:30528
  v_mfma_f32_16x16x32_bf16 v[240:243], a[52:55], v[48:51], v[240:243]
  v_mfma_f32_16x16x32_bf16 v[244:247], a[36:39], v[52:55], v[244:247]
  ds_read_b64_tr_b16 v[44:45], v2 offset:28768
  v_mfma_f32_16x16x32_bf16 v[248:251], a[44:47], v[52:55], v[248:251]
  ds_read_b64_tr_b16 v[46:47], v2 offset:30560
  v_mfma_f32_16x16x32_bf16 v[252:255], a[52:55], v[52:55], v[252:255]
  s_waitcnt lgkmcnt(4)
  s_waitcnt vmcnt(23)
  v_mfma_f32_16x16x32_bf16 v[172:175], a[132:135], v[56:59], v[172:175]
  ds_read_b64_tr_b16 v[48:49], v2 offset:28800
  s_barrier
  v_mfma_f32_16x16x32_bf16 v[176:179], a[140:143], v[56:59], v[176:179]
  ds_read_b64_tr_b16 v[50:51], v2 offset:30592
  v_mfma_f32_16x16x32_bf16 v[180:183], a[148:151], v[56:59], v[180:183]
  s_add_u32 m0, s33, 10240
  s_add_u32 s35, s90, 16384
  v_mfma_f32_16x16x32_bf16 v[184:187], a[132:135], v[60:63], v[184:187]
  ds_read_b64_tr_b16 v[52:53], v2 offset:28832
  buffer_load_dwordx4 v28, s[64:67], s35 offen nt lds
  v_mfma_f32_16x16x32_bf16 v[188:191], a[140:143], v[60:63], v[188:191]
  ds_read_b64_tr_b16 v[54:55], v2 offset:30624
  buffer_load_dwordx4 v29, s[64:67], s35 offen offset:1024 nt lds
  v_mfma_f32_16x16x32_bf16 v[192:195], a[148:151], v[60:63], v[192:195]
  s_waitcnt lgkmcnt(4)
  v_mfma_f32_16x16x32_bf16 v[196:199], a[132:135], v[40:43], v[196:199]
  ds_read_b64_tr_b16 v[56:57], v2 offset:28864
  v_mfma_f32_16x16x32_bf16 v[200:203], a[140:143], v[40:43], v[200:203]
  ds_read_b64_tr_b16 v[58:59], v2 offset:30656
  v_mfma_f32_16x16x32_bf16 v[204:207], a[148:151], v[40:43], v[204:207]
  v_mfma_f32_16x16x32_bf16 v[208:211], a[132:135], v[44:47], v[208:211]
  ds_read_b64_tr_b16 v[60:61], v2 offset:35840
  v_mfma_f32_16x16x32_bf16 v[212:215], a[140:143], v[44:47], v[212:215]
  ds_read_b64_tr_b16 v[62:63], v2 offset:37632
  v_mfma_f32_16x16x32_bf16 v[216:219], a[148:151], v[44:47], v[216:219]
  s_waitcnt lgkmcnt(4)
  v_mfma_f32_16x16x32_bf16 v[220:223], a[132:135], v[48:51], v[220:223]
  ds_read_b64_tr_b16 v[40:41], v2 offset:35872
  v_mfma_f32_16x16x32_bf16 v[224:227], a[140:143], v[48:51], v[224:227]
  ds_read_b64_tr_b16 v[42:43], v2 offset:37664
  v_mfma_f32_16x16x32_bf16 v[228:231], a[148:151], v[48:51], v[228:231]
  s_waitcnt vmcnt(14)
  ds_read_b128 a[56:59], v26 offset:0
  v_mfma_f32_16x16x32_bf16 v[232:235], a[132:135], v[52:55], v[232:235]
  ds_read_b64_tr_b16 v[44:45], v2 offset:35904
  v_mfma_f32_16x16x32_bf16 v[236:239], a[140:143], v[52:55], v[236:239]
  ds_read_b64_tr_b16 v[46:47], v2 offset:37696
  v_mfma_f32_16x16x32_bf16 v[240:243], a[148:151], v[52:55], v[240:243]
  s_waitcnt lgkmcnt(5)
  ds_read_b128 a[60:63], v27 offset:0
  v_mfma_f32_16x16x32_bf16 v[244:247], a[132:135], v[56:59], v[244:247]
  ds_read_b64_tr_b16 v[48:49], v2 offset:35936
  s_waitcnt lgkmcnt(1)
  v_mfma_f32_16x16x32_bf16 v[248:251], a[140:143], v[56:59], v[248:251]
  ds_read_b64_tr_b16 v[50:51], v2 offset:37728
  s_add_u32 m0, s33, 0
  v_mfma_f32_16x16x32_bf16 v[252:255], a[148:151], v[56:59], v[252:255]
  s_mul_i32 s90, s82, 24576
  s_add_u32 s90, s90, s85
  v_mfma_f32_16x16x32_bf16 v[172:175], a[136:139], v[60:63], v[172:175]
  ds_read_b64_tr_b16 v[52:53], v2 offset:35968
  s_add_u32 s35, s90, 0
  v_mfma_f32_16x16x32_bf16 v[176:179], a[144:147], v[60:63], v[176:179]
  ds_read_b64_tr_b16 v[54:55], v2 offset:37760
  buffer_load_dwordx4 v28, s[64:67], s35 offen nt lds
  v_mfma_f32_16x16x32_bf16 v[180:183], a[152:155], v[60:63], v[180:183]
  buffer_load_dwordx4 v29, s[64:67], s35 offen offset:1024 nt lds
  v_mfma_f32_16x16x32_bf16 v[184:187], a[136:139], v[40:43], v[184:187]
  ds_read_b64_tr_b16 v[56:57], v2 offset:36000
  s_waitcnt vmcnt(12)
  v_mfma_f32_16x16x32_bf16 v[188:191], a[144:147], v[40:43], v[188:191]
  ds_read_b64_tr_b16 v[58:59], v2 offset:37792
  v_mfma_f32_16x16x32_bf16 v[192:195], a[152:155], v[40:43], v[192:195]
  ds_read_b128 a[132:135], v26 offset:2048
  v_mfma_f32_16x16x32_bf16 v[196:199], a[136:139], v[44:47], v[196:199]
  ds_read_b64_tr_b16 v[60:61], v2 offset:36032
  ds_read_b128 a[64:67], v27 offset:2048
  v_mfma_f32_16x16x32_bf16 v[200:203], a[144:147], v[44:47], v[200:203]
  ds_read_b64_tr_b16 v[62:63], v2 offset:37824
  s_waitcnt lgkmcnt(1)
  v_mfma_f32_16x16x32_bf16 v[204:207], a[152:155], v[44:47], v[204:207]
  s_add_u32 m0, s33, 2048
  v_mfma_f32_16x16x32_bf16 v[208:211], a[136:139], v[48:51], v[208:211]
  ds_read_b64_tr_b16 v[40:41], v2 offset:43008
  s_add_u32 s35, s90, 8192
  v_mfma_f32_16x16x32_bf16 v[212:215], a[144:147], v[48:51], v[212:215]
  ds_read_b64_tr_b16 v[42:43], v2 offset:44800
  buffer_load_dwordx4 v28, s[64:67], s35 offen nt lds
  v_mfma_f32_16x16x32_bf16 v[216:219], a[152:155], v[48:51], v[216:219]
  buffer_load_dwordx4 v29, s[64:67], s35 offen offset:1024 nt lds
  v_mfma_f32_16x16x32_bf16 v[220:223], a[136:139], v[52:55], v[220:223]
  ds_read_b64_tr_b16 v[44:45], v2 offset:43040
  v_mfma_f32_16x16x32_bf16 v[224:227], a[144:147], v[52:55], v[224:227]
  ds_read_b64_tr_b16 v[46:47], v2 offset:44832
  s_waitcnt vmcnt(10)
  v_mfma_f32_16x16x32_bf16 v[228:231], a[152:155], v[52:55], v[228:231]
  s_waitcnt lgkmcnt(4)
  ds_read_b128 a[140:143], v26 offset:4096
  v_mfma_f32_16x16x32_bf16 v[232:235], a[136:139], v[56:59], v[232:235]
  ds_read_b64_tr_b16 v[48:49], v2 offset:43072
  v_mfma_f32_16x16x32_bf16 v[236:239], a[144:147], v[56:59], v[236:239]
  ds_read_b64_tr_b16 v[50:51], v2 offset:44864
  ds_read_b128 a[148:151], v27 offset:4096
  v_mfma_f32_16x16x32_bf16 v[240:243], a[152:155], v[56:59], v[240:243]
  s_waitcnt lgkmcnt(0)
  s_add_u32 m0, s33, 4096
  v_mfma_f32_16x16x32_bf16 v[244:247], a[136:139], v[60:63], v[244:247]
  ds_read_b64_tr_b16 v[52:53], v2 offset:43104
  s_add_u32 s35, s90, 16384
  v_mfma_f32_16x16x32_bf16 v[248:251], a[144:147], v[60:63], v[248:251]
  ds_read_b64_tr_b16 v[54:55], v2 offset:44896
  buffer_load_dwordx4 v28, s[64:67], s35 offen nt lds
  v_mfma_f32_16x16x32_bf16 v[252:255], a[152:155], v[60:63], v[252:255]
  buffer_load_dwordx4 v29, s[64:67], s35 offen offset:1024 nt lds
  v_mfma_f32_16x16x32_bf16 v[172:175], a[156:159], v[40:43], v[172:175]
  ds_read_b64_tr_b16 v[56:57], v2 offset:43136
  v_mfma_f32_16x16x32_bf16 v[176:179], a[164:167], v[40:43], v[176:179]
  ds_read_b64_tr_b16 v[58:59], v2 offset:44928
  v_mfma_f32_16x16x32_bf16 v[180:183], a[172:175], v[40:43], v[180:183]
  s_waitcnt vmcnt(10)
  ds_read_b128 a[68:71], v26 offset:6144
  v_mfma_f32_16x16x32_bf16 v[184:187], a[156:159], v[44:47], v[184:187]
  ds_read_b64_tr_b16 v[60:61], v2 offset:43168
  v_mfma_f32_16x16x32_bf16 v[188:191], a[164:167], v[44:47], v[188:191]
  ds_read_b64_tr_b16 v[62:63], v2 offset:44960
  v_mfma_f32_16x16x32_bf16 v[192:195], a[172:175], v[44:47], v[192:195]
  s_waitcnt lgkmcnt(5)
  ds_read_b128 a[72:75], v27 offset:6144
  v_mfma_f32_16x16x32_bf16 v[196:199], a[156:159], v[48:51], v[196:199]
  ds_read_b64_tr_b16 v[40:41], v2 offset:43200
  s_waitcnt lgkmcnt(1)
  v_mfma_f32_16x16x32_bf16 v[200:203], a[164:167], v[48:51], v[200:203]
  ds_read_b64_tr_b16 v[42:43], v2 offset:44992
  s_add_u32 m0, s33, 6144
  v_mfma_f32_16x16x32_bf16 v[204:207], a[172:175], v[48:51], v[204:207]
  s_mul_i32 s90, s82, 24576
  s_add_u32 s90, s90, s86
  v_mfma_f32_16x16x32_bf16 v[208:211], a[156:159], v[52:55], v[208:211]
  ds_read_b64_tr_b16 v[44:45], v2 offset:50176
  s_add_u32 s35, s90, 0
  v_mfma_f32_16x16x32_bf16 v[212:215], a[164:167], v[52:55], v[212:215]
  ds_read_b64_tr_b16 v[46:47], v2 offset:51968
  buffer_load_dwordx4 v28, s[64:67], s35 offen nt lds
  v_mfma_f32_16x16x32_bf16 v[216:219], a[172:175], v[52:55], v[216:219]
  buffer_load_dwordx4 v29, s[64:67], s35 offen offset:1024 nt lds
  v_mfma_f32_16x16x32_bf16 v[220:223], a[156:159], v[56:59], v[220:223]
  ds_read_b64_tr_b16 v[48:49], v2 offset:50208
  s_waitcnt vmcnt(10)
  v_mfma_f32_16x16x32_bf16 v[224:227], a[164:167], v[56:59], v[224:227]
  ds_read_b64_tr_b16 v[50:51], v2 offset:52000
  v_mfma_f32_16x16x32_bf16 v[228:231], a[172:175], v[56:59], v[228:231]
  ds_read_b128 a[136:139], v26 offset:8192
  v_mfma_f32_16x16x32_bf16 v[232:235], a[156:159], v[60:63], v[232:235]
  ds_read_b64_tr_b16 v[52:53], v2 offset:50240
  ds_read_b128 a[76:79], v27 offset:8192
  v_mfma_f32_16x16x32_bf16 v[236:239], a[164:167], v[60:63], v[236:239]
  ds_read_b64_tr_b16 v[54:55], v2 offset:52032
  s_waitcnt lgkmcnt(1)
  v_mfma_f32_16x16x32_bf16 v[240:243], a[172:175], v[60:63], v[240:243]
  s_add_u32 m0, s33, 8192
  v_mfma_f32_16x16x32_bf16 v[244:247], a[156:159], v[40:43], v[244:247]
  ds_read_b64_tr_b16 v[56:57], v2 offset:50272
  s_add_u32 s35, s90, 8192
  v_mfma_f32_16x16x32_bf16 v[248:251], a[164:167], v[40:43], v[248:251]
  ds_read_b64_tr_b16 v[58:59], v2 offset:52064
  buffer_load_dwordx4 v28, s[64:67], s35 offen nt lds
  v_mfma_f32_16x16x32_bf16 v[252:255], a[172:175], v[40:43], v[252:255]
  buffer_load_dwordx4 v29, s[64:67], s35 offen offset:1024 nt lds
  v_mfma_f32_16x16x32_bf16 v[172:175], a[160:163], v[44:47], v[172:175]
  ds_read_b64_tr_b16 v[60:61], v2 offset:50304
  v_mfma_f32_16x16x32_bf16 v[176:179], a[168:171], v[44:47], v[176:179]
  ds_read_b64_tr_b16 v[62:63], v2 offset:52096
  s_waitcnt vmcnt(10)
  v_mfma_f32_16x16x32_bf16 v[180:183], a[176:179], v[44:47], v[180:183]
  s_waitcnt lgkmcnt(4)
  ds_read_b128 a[144:147], v26 offset:10240
  v_mfma_f32_16x16x32_bf16 v[184:187], a[160:163], v[48:51], v[184:187]
  ds_read_b64_tr_b16 v[40:41], v2 offset:50336
  v_mfma_f32_16x16x32_bf16 v[188:191], a[168:171], v[48:51], v[188:191]
  ds_read_b64_tr_b16 v[42:43], v2 offset:52128
  ds_read_b128 a[80:83], v27 offset:10240
  v_mfma_f32_16x16x32_bf16 v[192:195], a[176:179], v[48:51], v[192:195]
  s_waitcnt lgkmcnt(0)
  s_add_u32 m0, s33, 10240
  v_mfma_f32_16x16x32_bf16 v[196:199], a[160:163], v[52:55], v[196:199]
  ds_read_b64_tr_b16 v[44:45], v2 offset:50368
  s_add_u32 s35, s90, 16384
  v_mfma_f32_16x16x32_bf16 v[200:203], a[168:171], v[52:55], v[200:203]
  ds_read_b64_tr_b16 v[46:47], v2 offset:52160
  buffer_load_dwordx4 v28, s[64:67], s35 offen nt lds
  v_mfma_f32_16x16x32_bf16 v[204:207], a[176:179], v[52:55], v[204:207]
  buffer_load_dwordx4 v29, s[64:67], s35 offen offset:1024 nt lds
  v_mfma_f32_16x16x32_bf16 v[208:211], a[160:163], v[56:59], v[208:211]
  ds_read_b64_tr_b16 v[48:49], v3 offset:0
  v_cvt_pk_bf16_f32 v64, v172, v173
  v_mfma_f32_16x16x32_bf16 v[212:215], a[168:171], v[56:59], v[212:215]
  ds_read_b64_tr_b16 v[50:51], v3 offset:1792
  v_cvt_pk_bf16_f32 v65, v174, v175
  v_mfma_f32_16x16x32_bf16 v[216:219], a[176:179], v[56:59], v[216:219]
  v_cvt_pk_bf16_f32 v66, v176, v177
  v_cvt_pk_bf16_f32 v67, v178, v179
  v_mfma_f32_16x16x32_bf16 v[220:223], a[160:163], v[60:63], v[220:223]
  ds_read_b64_tr_b16 v[52:53], v3 offset:32
  v_cvt_pk_bf16_f32 v68, v180, v181
  v_mfma_f32_16x16x32_bf16 v[224:227], a[168:171], v[60:63], v[224:227]
  ds_read_b64_tr_b16 v[54:55], v3 offset:1824
  v_cvt_pk_bf16_f32 v69, v182, v183
  v_mfma_f32_16x16x32_bf16 v[228:231], a[176:179], v[60:63], v[228:231]
  s_waitcnt lgkmcnt(4)
  v_cvt_pk_bf16_f32 v76, v184, v185
  v_mfma_f32_16x16x32_bf16 v[232:235], a[160:163], v[40:43], v[232:235]
  ds_read_b64_tr_b16 v[56:57], v3 offset:64
  v_cvt_pk_bf16_f32 v77, v186, v187
  v_mfma_f32_16x16x32_bf16 v[236:239], a[168:171], v[40:43], v[236:239]
  ds_read_b64_tr_b16 v[58:59], v3 offset:1856
  v_cvt_pk_bf16_f32 v78, v188, v189
  v_cvt_pk_bf16_f32 v79, v190, v191
  v_mfma_f32_16x16x32_bf16 v[240:243], a[176:179], v[40:43], v[240:243]
  v_cvt_pk_bf16_f32 v80, v192, v193
  v_cvt_pk_bf16_f32 v81, v194, v195
  v_mfma_f32_16x16x32_bf16 v[244:247], a[160:163], v[44:47], v[244:247]
  ds_read_b64_tr_b16 v[60:61], v3 offset:96
  v_cvt_pk_bf16_f32 v88, v196, v197
  v_cvt_pk_bf16_f32 v89, v198, v199
  v_mfma_f32_16x16x32_bf16 v[248:251], a[168:171], v[44:47], v[248:251]
  ds_read_b64_tr_b16 v[62:63], v3 offset:1888
  v_cvt_pk_bf16_f32 v90, v200, v201
  v_cvt_pk_bf16_f32 v91, v202, v203
  v_mfma_f32_16x16x32_bf16 v[252:255], a[176:179], v[44:47], v[252:255]
  s_waitcnt lgkmcnt(4)
  v_cvt_pk_bf16_f32 v92, v204, v205
  v_cvt_pk_bf16_f32 v93, v206, v207
  v_mfma_f32_16x16x32_bf16 v[172:175], a[180:183], v[48:51], 0
  ds_read_b64_tr_b16 v[40:41], v3 offset:128
  v_cvt_pk_bf16_f32 v100, v208, v209
  v_cvt_pk_bf16_f32 v101, v210, v211
  s_add_u32 m0, s34, 0
  s_mul_i32 s91, s82, 229376
  s_add_u32 s91, s91, s88
  buffer_load_dwordx4 v30, s[68:71], s91 offen offset:0 lds
  v_mfma_f32_16x16x32_bf16 v[176:179], a[188:191], v[48:51], 0
  ds_read_b64_tr_b16 v[42:43], v3 offset:1920
  v_cvt_pk_bf16_f32 v102, v212, v213
  v_cvt_pk_bf16_f32 v103, v214, v215
  v_mov_b32 v39, s57
  s_lshl_b32 s31, s22, 7
  s_mov_b64 exec, 1
  buffer_store_dword v39, v7, s[16:19], s31 offen sc1
  s_mov_b64 exec, -1
  v_mfma_f32_16x16x32_bf16 v[180:183], a[196:199], v[48:51], 0
  v_cvt_pk_bf16_f32 v104, v216, v217
  v_cvt_pk_bf16_f32 v105, v218, v219
  v_cvt_pk_bf16_f32 v112, v220, v221
  v_cvt_pk_bf16_f32 v113, v222, v223
  v_cvt_pk_bf16_f32 v114, v224, v225
  v_cvt_pk_bf16_f32 v115, v226, v227
  buffer_load_dwordx4 v31, s[68:71], s91 offen offset:1024 lds
  v_cvt_pk_bf16_f32 v116, v228, v229
  v_cvt_pk_bf16_f32 v117, v230, v231
  s_barrier
  s_waitcnt vmcnt(13)
  ds_read_b128 a[172:175], v26 offset:0
  ds_read_b128 a[84:87], v27 offset:0
  v_mfma_f32_16x16x32_bf16 v[184:187], a[180:183], v[52:55], 0
  ds_read_b64_tr_b16 v[44:45], v3 offset:160
  v_cvt_pk_bf16_f32 v124, v232, v233
  v_mfma_f32_16x16x32_bf16 v[188:191], a[188:191], v[52:55], 0
  ds_read_b64_tr_b16 v[46:47], v3 offset:1952
  v_cvt_pk_bf16_f32 v125, v234, v235
  v_mfma_f32_16x16x32_bf16 v[192:195], a[196:199], v[52:55], 0
  s_waitcnt lgkmcnt(6)
  v_cvt_pk_bf16_f32 v126, v236, v237
  v_mfma_f32_16x16x32_bf16 v[196:199], a[180:183], v[56:59], 0
  ds_read_b64_tr_b16 v[48:49], v3 offset:192
  v_cvt_pk_bf16_f32 v127, v238, v239
  v_mfma_f32_16x16x32_bf16 v[200:203], a[188:191], v[56:59], 0
  ds_read_b64_tr_b16 v[50:51], v3 offset:1984
  v_cvt_pk_bf16_f32 v128, v240, v241
  v_mfma_f32_16x16x32_bf16 v[204:207], a[196:199], v[56:59], 0
  v_cvt_pk_bf16_f32 v129, v242, v243
  buffer_load_dwordx4 v32, s[68:71], s91 offen offset:2048 lds
  v_mfma_f32_16x16x32_bf16 v[208:211], a[180:183], v[60:63], 0
  ds_read_b64_tr_b16 v[52:53], v3 offset:7168
  v_cvt_pk_bf16_f32 v136, v244, v245
  v_cvt_pk_bf16_f32 v137, v246, v247
  v_mfma_f32_16x16x32_bf16 v[212:215], a[188:191], v[60:63], 0
  ds_read_b64_tr_b16 v[54:55], v3 offset:8960
  v_cvt_pk_bf16_f32 v138, v248, v249
  v_cvt_pk_bf16_f32 v139, v250, v251
  v_mfma_f32_16x16x32_bf16 v[216:219], a[196:199], v[60:63], 0
  s_waitcnt lgkmcnt(4)
  v_cvt_pk_bf16_f32 v140, v252, v253
  v_cvt_pk_bf16_f32 v141, v254, v255
  v_mfma_f32_16x16x32_bf16 v[220:223], a[180:183], v[40:43], 0
  ds_read_b64_tr_b16 v[56:57], v3 offset:7200
  buffer_load_dwordx4 v33, s[68:71], s91 offen offset:3072 lds
  s_waitcnt vmcnt(13)
  ds_read_b128 a[168:171], v26 offset:2048
  ds_read_b128 a[176:179], v27 offset:2048
  v_mfma_f32_16x16x32_bf16 v[224:227], a[188:191], v[40:43], 0
  ds_read_b64_tr_b16 v[58:59], v3 offset:8992
  s_add_u32 m0, s34, 4096
  v_mfma_f32_16x16x32_bf16 v[228:231], a[196:199], v[40:43], 0
  s_nop 0
  buffer_load_dwordx4 v34, s[68:71], s91 offen offset:0 lds
  v_mfma_f32_16x16x32_bf16 v[232:235], a[180:183], v[44:47], 0
  ds_read_b64_tr_b16 v[60:61], v3 offset:7232
  buffer_load_dwordx4 v35, s[68:71], s91 offen offset:1024 lds
  v_mfma_f32_16x16x32_bf16 v[236:239], a[188:191], v[44:47], 0
  ds_read_b64_tr_b16 v[62:63], v3 offset:9024
  v_mfma_f32_16x16x32_bf16 v[240:243], a[196:199], v[44:47], 0
  s_waitcnt lgkmcnt(6)
  v_mfma_f32_16x16x32_bf16 v[244:247], a[180:183], v[48:51], 0
  ds_read_b64_tr_b16 v[40:41], v3 offset:7264
  buffer_load_dwordx4 v36, s[68:71], s91 offen offset:2048 lds
  v_mfma_f32_16x16x32_bf16 v[248:251], a[188:191], v[48:51], 0
  ds_read_b64_tr_b16 v[42:43], v3 offset:9056
  s_waitcnt vmcnt(14)
  v_mfma_f32_16x16x32_bf16 v[252:255], a[196:199], v[48:51], 0
  ds_read_b128 a[88:91], v26 offset:4096
  v_mfma_f32_16x16x32_bf16 v[172:175], a[184:187], v[52:55], v[172:175]
  ds_read_b64_tr_b16 v[44:45], v3 offset:7296
  v_mfma_f32_16x16x32_bf16 v[176:179], a[192:195], v[52:55], v[176:179]
  ds_read_b64_tr_b16 v[46:47], v3 offset:9088
  ds_read_b128 a[92:95], v27 offset:4096
  v_mfma_f32_16x16x32_bf16 v[180:183], a[200:203], v[52:55], v[180:183]
  s_waitcnt lgkmcnt(6)
  s_add_u32 m0, s34, 28672
  v_mfma_f32_16x16x32_bf16 v[184:187], a[184:187], v[56:59], v[184:187]
  ds_read_b64_tr_b16 v[48:49], v3 offset:7328
  s_mul_i32 s91, s82, 229376
  v_mfma_f32_16x16x32_bf16 v[188:191], a[192:195], v[56:59], v[188:191]
  ds_read_b64_tr_b16 v[50:51], v3 offset:9120
  s_add_u32 s91, s91, s89
  v_mfma_f32_16x16x32_bf16 v[192:195], a[200:203], v[56:59], v[192:195]
  buffer_load_dwordx4 v30, s[68:71], s91 offen offset:0 lds
  buffer_load_dwordx4 v31, s[68:71], s91 offen offset:1024 lds
  v_mfma_f32_16x16x32_bf16 v[196:199], a[184:187], v[60:63], v[196:199]
  ds_read_b64_tr_b16 v[52:53], v3 offset:7360
  v_mfma_f32_16x16x32_bf16 v[200:203], a[192:195], v[60:63], v[200:203]
  ds_read_b64_tr_b16 v[54:55], v3 offset:9152
  v_mfma_f32_16x16x32_bf16 v[204:207], a[200:203], v[60:63], v[204:207]
  s_waitcnt lgkmcnt(5)
  s_waitcnt vmcnt(14)
  v_mfma_f32_16x16x32_bf16 v[208:211], a[184:187], v[40:43], v[208:211]
  ds_read_b64_tr_b16 v[56:57], v3 offset:14336
  v_mfma_f32_16x16x32_bf16 v[212:215], a[192:195], v[40:43], v[212:215]
  ds_read_b64_tr_b16 v[58:59], v3 offset:16128
  v_mfma_f32_16x16x32_bf16 v[216:219], a[200:203], v[40:43], v[216:219]
  ds_read_b128 a[180:183], v26 offset:6144
  ds_read_b128 a[188:191], v27 offset:6144
  v_mfma_f32_16x16x32_bf16 v[220:223], a[184:187], v[44:47], v[220:223]
  ds_read_b64_tr_b16 v[60:61], v3 offset:14368
  buffer_load_dwordx4 v32, s[68:71], s91 offen offset:2048 lds
  v_mfma_f32_16x16x32_bf16 v[224:227], a[192:195], v[44:47], v[224:227]
  ds_read_b64_tr_b16 v[62:63], v3 offset:16160
  buffer_load_dwordx4 v33, s[68:71], s91 offen offset:3072 lds
  v_mfma_f32_16x16x32_bf16 v[228:231], a[200:203], v[44:47], v[228:231]
  s_waitcnt lgkmcnt(6)
  v_mfma_f32_16x16x32_bf16 v[232:235], a[184:187], v[48:51], v[232:235]
  ds_read_b64_tr_b16 v[40:41], v3 offset:14400
  v_mfma_f32_16x16x32_bf16 v[236:239], a[192:195], v[48:51], v[236:239]
  ds_read_b64_tr_b16 v[42:43], v3 offset:16192
  v_mfma_f32_16x16x32_bf16 v[240:243], a[200:203], v[48:51], v[240:243]
  s_add_u32 m0, s34, 32768
  s_nop 0
  v_mfma_f32_16x16x32_bf16 v[244:247], a[184:187], v[52:55], v[244:247]
  ds_read_b64_tr_b16 v[44:45], v3 offset:14432
  buffer_load_dwordx4 v34, s[68:71], s91 offen offset:0 lds
  v_mfma_f32_16x16x32_bf16 v[248:251], a[192:195], v[52:55], v[248:251]
  ds_read_b64_tr_b16 v[46:47], v3 offset:16224
  s_waitcnt vmcnt(15)
  v_mfma_f32_16x16x32_bf16 v[252:255], a[200:203], v[52:55], v[252:255]
  s_waitcnt lgkmcnt(4)
  ds_read_b128 a[196:199], v26 offset:8192
  v_mfma_f32_16x16x32_bf16 v[172:175], a[204:207], v[56:59], v[172:175]
  ds_read_b64_tr_b16 v[48:49], v3 offset:14464
  ds_read_b128 a[96:99], v27 offset:8192
  v_mfma_f32_16x16x32_bf16 v[176:179], a[212:215], v[56:59], v[176:179]
  ds_read_b64_tr_b16 v[50:51], v3 offset:16256
  buffer_load_dwordx4 v35, s[68:71], s91 offen offset:1024 lds
  v_mfma_f32_16x16x32_bf16 v[180:183], a[220:223], v[56:59], v[180:183]
  v_mfma_f32_16x16x32_bf16 v[184:187], a[204:207], v[60:63], v[184:187]
  ds_read_b64_tr_b16 v[52:53], v3 offset:14496
  v_mfma_f32_16x16x32_bf16 v[188:191], a[212:215], v[60:63], v[188:191]
  ds_read_b64_tr_b16 v[54:55], v3 offset:16288
  buffer_load_dwordx4 v36, s[68:71], s91 offen offset:2048 lds
  v_mfma_f32_16x16x32_bf16 v[192:195], a[220:223], v[60:63], v[192:195]
  s_waitcnt lgkmcnt(6)
  v_mfma_f32_16x16x32_bf16 v[196:199], a[204:207], v[40:43], v[196:199]
  ds_read_b64_tr_b16 v[56:57], v3 offset:14528
  v_mfma_f32_16x16x32_bf16 v[200:203], a[212:215], v[40:43], v[200:203]
  ds_read_b64_tr_b16 v[58:59], v3 offset:16320
  s_waitcnt vmcnt(15)
  v_mfma_f32_16x16x32_bf16 v[204:207], a[220:223], v[40:43], v[204:207]
  ds_read_b128 a[184:187], v26 offset:10240
  v_mfma_f32_16x16x32_bf16 v[208:211], a[204:207], v[44:47], v[208:211]
  ds_read_b64_tr_b16 v[60:61], v3 offset:21504
  v_mfma_f32_16x16x32_bf16 v[212:215], a[212:215], v[44:47], v[212:215]
  ds_read_b64_tr_b16 v[62:63], v3 offset:23296
  ds_read_b128 a[192:195], v27 offset:10240
  v_mfma_f32_16x16x32_bf16 v[216:219], a[220:223], v[44:47], v[216:219]
  s_waitcnt lgkmcnt(6)
  v_mfma_f32_16x16x32_bf16 v[220:223], a[204:207], v[48:51], v[220:223]
  ds_read_b64_tr_b16 v[40:41], v3 offset:21536
  s_add_u32 m0, s33, 0
  v_mfma_f32_16x16x32_bf16 v[224:227], a[212:215], v[48:51], v[224:227]
  ds_read_b64_tr_b16 v[42:43], v3 offset:23328
  s_mul_i32 s90, s82, 24576
  v_mfma_f32_16x16x32_bf16 v[228:231], a[220:223], v[48:51], v[228:231]
  s_add_u32 s90, s90, s87
  s_add_u32 s35, s90, 0
  buffer_load_dwordx4 v28, s[64:67], s35 offen nt lds
  buffer_load_dwordx4 v29, s[64:67], s35 offen offset:1024 nt lds
  v_mfma_f32_16x16x32_bf16 v[232:235], a[204:207], v[52:55], v[232:235]
  ds_read_b64_tr_b16 v[44:45], v3 offset:21568
  v_mfma_f32_16x16x32_bf16 v[236:239], a[212:215], v[52:55], v[236:239]
  ds_read_b64_tr_b16 v[46:47], v3 offset:23360
  v_mfma_f32_16x16x32_bf16 v[240:243], a[220:223], v[52:55], v[240:243]
  s_waitcnt lgkmcnt(5)
  v_mfma_f32_16x16x32_bf16 v[244:247], a[204:207], v[56:59], v[244:247]
  ds_read_b64_tr_b16 v[48:49], v3 offset:21600
  v_mfma_f32_16x16x32_bf16 v[248:251], a[212:215], v[56:59], v[248:251]
  ds_read_b64_tr_b16 v[50:51], v3 offset:23392
  s_add_u32 m0, s33, 2048
  v_mfma_f32_16x16x32_bf16 v[252:255], a[220:223], v[56:59], v[252:255]
  s_add_u32 s35, s90, 8192
  buffer_load_dwordx4 v28, s[64:67], s35 offen nt lds
  v_mfma_f32_16x16x32_bf16 v[172:175], a[208:211], v[60:63], v[172:175]
  ds_read_b64_tr_b16 v[52:53], v3 offset:21632
  buffer_load_dwordx4 v29, s[64:67], s35 offen offset:1024 nt lds
  v_mfma_f32_16x16x32_bf16 v[176:179], a[216:219], v[60:63], v[176:179]
  ds_read_b64_tr_b16 v[54:55], v3 offset:23424
  v_mfma_f32_16x16x32_bf16 v[180:183], a[224:227], v[60:63], v[180:183]
  s_waitcnt lgkmcnt(4)
  v_mfma_f32_16x16x32_bf16 v[184:187], a[208:211], v[40:43], v[184:187]
  ds_read_b64_tr_b16 v[56:57], v3 offset:21664
  v_mfma_f32_16x16x32_bf16 v[188:191], a[216:219], v[40:43], v[188:191]
  ds_read_b64_tr_b16 v[58:59], v3 offset:23456
  v_mfma_f32_16x16x32_bf16 v[192:195], a[224:227], v[40:43], v[192:195]
  v_mfma_f32_16x16x32_bf16 v[196:199], a[208:211], v[44:47], v[196:199]
  ds_read_b64_tr_b16 v[60:61], v3 offset:21696
  v_mfma_f32_16x16x32_bf16 v[200:203], a[216:219], v[44:47], v[200:203]
  ds_read_b64_tr_b16 v[62:63], v3 offset:23488
  v_mfma_f32_16x16x32_bf16 v[204:207], a[224:227], v[44:47], v[204:207]
  s_waitcnt lgkmcnt(4)
  s_add_u32 m0, s33, 4096
  v_mfma_f32_16x16x32_bf16 v[208:211], a[208:211], v[48:51], v[208:211]
  ds_read_b64_tr_b16 v[40:41], v3 offset:28672
  s_add_u32 s35, s90, 16384
  v_mfma_f32_16x16x32_bf16 v[212:215], a[216:219], v[48:51], v[212:215]
  ds_read_b64_tr_b16 v[42:43], v3 offset:30464
  buffer_load_dwordx4 v28, s[64:67], s35 offen nt lds
  v_mfma_f32_16x16x32_bf16 v[216:219], a[224:227], v[48:51], v[216:219]
  buffer_load_dwordx4 v29, s[64:67], s35 offen offset:1024 nt lds
  v_mfma_f32_16x16x32_bf16 v[220:223], a[208:211], v[52:55], v[220:223]
  ds_read_b64_tr_b16 v[44:45], v3 offset:28704
  v_mfma_f32_16x16x32_bf16 v[224:227], a[216:219], v[52:55], v[224:227]
  ds_read_b64_tr_b16 v[46:47], v3 offset:30496
  v_mfma_f32_16x16x32_bf16 v[228:231], a[224:227], v[52:55], v[228:231]
  s_waitcnt lgkmcnt(4)
  v_mfma_f32_16x16x32_bf16 v[232:235], a[208:211], v[56:59], v[232:235]
  ds_read_b64_tr_b16 v[48:49], v3 offset:28736
  v_mfma_f32_16x16x32_bf16 v[236:239], a[216:219], v[56:59], v[236:239]
  ds_read_b64_tr_b16 v[50:51], v3 offset:30528
  v_mfma_f32_16x16x32_bf16 v[240:243], a[224:227], v[56:59], v[240:243]
  s_add_u32 m0, s33, 6144
  v_mfma_f32_16x16x32_bf16 v[244:247], a[208:211], v[60:63], v[244:247]
  ds_read_b64_tr_b16 v[52:53], v3 offset:28768
  s_mul_i32 s90, s83, 24576
  v_mfma_f32_16x16x32_bf16 v[248:251], a[216:219], v[60:63], v[248:251]
  ds_read_b64_tr_b16 v[54:55], v3 offset:30560
  s_add_u32 s90, s90, s84
  v_mfma_f32_16x16x32_bf16 v[252:255], a[224:227], v[60:63], v[252:255]
  s_waitcnt lgkmcnt(4)
  s_add_u32 s35, s90, 0
  v_mfma_f32_16x16x32_bf16 v[172:175], a[228:231], v[40:43], v[172:175]
  ds_read_b64_tr_b16 v[56:57], v3 offset:28800
  buffer_load_dwordx4 v28, s[64:67], s35 offen nt lds
  v_mfma_f32_16x16x32_bf16 v[176:179], a[236:239], v[40:43], v[176:179]
  ds_read_b64_tr_b16 v[58:59], v3 offset:30592
  buffer_load_dwordx4 v29, s[64:67], s35 offen offset:1024 nt lds
  v_mfma_f32_16x16x32_bf16 v[180:183], a[244:247], v[40:43], v[180:183]
  s_waitcnt vmcnt(15)
  s_barrier
  v_mfma_f32_16x16x32_bf16 v[184:187], a[228:231], v[44:47], v[184:187]
  ds_read_b64_tr_b16 v[60:61], v3 offset:28832
  v_mfma_f32_16x16x32_bf16 v[188:191], a[236:239], v[44:47], v[188:191]
  ds_read_b64_tr_b16 v[62:63], v3 offset:30624
  v_mfma_f32_16x16x32_bf16 v[192:195], a[244:247], v[44:47], v[192:195]
  s_waitcnt lgkmcnt(4)
  v_mfma_f32_16x16x32_bf16 v[196:199], a[228:231], v[48:51], v[196:199]
  ds_read_b64_tr_b16 v[40:41], v3 offset:28864
  v_mfma_f32_16x16x32_bf16 v[200:203], a[236:239], v[48:51], v[200:203]
  ds_read_b64_tr_b16 v[42:43], v3 offset:30656
  s_add_u32 m0, s33, 8192
  v_mfma_f32_16x16x32_bf16 v[204:207], a[244:247], v[48:51], v[204:207]
  s_add_u32 s35, s90, 8192
  buffer_load_dwordx4 v28, s[64:67], s35 offen nt lds
  v_mfma_f32_16x16x32_bf16 v[208:211], a[228:231], v[52:55], v[208:211]
  ds_read_b64_tr_b16 v[44:45], v3 offset:35840
  buffer_load_dwordx4 v29, s[64:67], s35 offen offset:1024 nt lds
  v_mfma_f32_16x16x32_bf16 v[212:215], a[236:239], v[52:55], v[212:215]
  ds_read_b64_tr_b16 v[46:47], v3 offset:37632
  v_mfma_f32_16x16x32_bf16 v[216:219], a[244:247], v[52:55], v[216:219]
  s_waitcnt lgkmcnt(4)
  v_mfma_f32_16x16x32_bf16 v[220:223], a[228:231], v[56:59], v[220:223]
  ds_read_b64_tr_b16 v[48:49], v3 offset:35872
  v_mfma_f32_16x16x32_bf16 v[224:227], a[236:239], v[56:59], v[224:227]
  ds_read_b64_tr_b16 v[50:51], v3 offset:37664
  v_mfma_f32_16x16x32_bf16 v[228:231], a[244:247], v[56:59], v[228:231]
  v_mfma_f32_16x16x32_bf16 v[232:235], a[228:231], v[60:63], v[232:235]
  ds_read_b64_tr_b16 v[52:53], v3 offset:35904
  v_mfma_f32_16x16x32_bf16 v[236:239], a[236:239], v[60:63], v[236:239]
  ds_read_b64_tr_b16 v[54:55], v3 offset:37696
  v_mfma_f32_16x16x32_bf16 v[240:243], a[244:247], v[60:63], v[240:243]
  s_waitcnt lgkmcnt(4)
  s_add_u32 m0, s33, 10240
  v_mfma_f32_16x16x32_bf16 v[244:247], a[228:231], v[40:43], v[244:247]
  ds_read_b64_tr_b16 v[56:57], v3 offset:35936
  s_add_u32 s35, s90, 16384
  v_mfma_f32_16x16x32_bf16 v[248:251], a[236:239], v[40:43], v[248:251]
  ds_read_b64_tr_b16 v[58:59], v3 offset:37728
  buffer_load_dwordx4 v28, s[64:67], s35 offen nt lds
  v_mfma_f32_16x16x32_bf16 v[252:255], a[244:247], v[40:43], v[252:255]
  buffer_load_dwordx4 v29, s[64:67], s35 offen offset:1024 nt lds
  v_mfma_f32_16x16x32_bf16 v[172:175], a[232:235], v[44:47], v[172:175]
  ds_read_b64_tr_b16 v[60:61], v3 offset:35968
  v_mfma_f32_16x16x32_bf16 v[176:179], a[240:243], v[44:47], v[176:179]
  ds_read_b64_tr_b16 v[62:63], v3 offset:37760
  v_mfma_f32_16x16x32_bf16 v[180:183], a[248:251], v[44:47], v[180:183]
  s_waitcnt lgkmcnt(4)
  v_mfma_f32_16x16x32_bf16 v[184:187], a[232:235], v[48:51], v[184:187]
  ds_read_b64_tr_b16 v[40:41], v3 offset:36000
  v_mfma_f32_16x16x32_bf16 v[188:191], a[240:243], v[48:51], v[188:191]
  ds_read_b64_tr_b16 v[42:43], v3 offset:37792
  v_mfma_f32_16x16x32_bf16 v[192:195], a[248:251], v[48:51], v[192:195]
  v_mfma_f32_16x16x32_bf16 v[196:199], a[232:235], v[52:55], v[196:199]
  ds_read_b64_tr_b16 v[44:45], v3 offset:36032
  v_mfma_f32_16x16x32_bf16 v[200:203], a[240:243], v[52:55], v[200:203]
  ds_read_b64_tr_b16 v[46:47], v3 offset:37824
  v_mfma_f32_16x16x32_bf16 v[204:207], a[248:251], v[52:55], v[204:207]
  s_waitcnt lgkmcnt(4)
  v_mfma_f32_16x16x32_bf16 v[208:211], a[232:235], v[56:59], v[208:211]
  ds_read_b64_tr_b16 v[48:49], v3 offset:43008
  v_mfma_f32_16x16x32_bf16 v[212:215], a[240:243], v[56:59], v[212:215]
  ds_read_b64_tr_b16 v[50:51], v3 offset:44800
  s_waitcnt vmcnt(10)
  v_mfma_f32_16x16x32_bf16 v[216:219], a[248:251], v[56:59], v[216:219]
  ds_read_b128 a[200:203], v26 offset:0
  v_mfma_f32_16x16x32_bf16 v[220:223], a[232:235], v[60:63], v[220:223]
  ds_read_b64_tr_b16 v[52:53], v3 offset:43040
  v_mfma_f32_16x16x32_bf16 v[224:227], a[240:243], v[60:63], v[224:227]
  ds_read_b64_tr_b16 v[54:55], v3 offset:44832
  ds_read_b128 a[100:103], v27 offset:0
  v_mfma_f32_16x16x32_bf16 v[228:231], a[248:251], v[60:63], v[228:231]
  s_waitcnt lgkmcnt(6)
  s_waitcnt lgkmcnt(0)
  v_mfma_f32_16x16x32_bf16 v[232:235], a[232:235], v[40:43], v[232:235]
  ds_read_b64_tr_b16 v[56:57], v3 offset:43072
  s_add_u32 m0, s33, 0
  v_mfma_f32_16x16x32_bf16 v[236:239], a[240:243], v[40:43], v[236:239]
  ds_read_b64_tr_b16 v[58:59], v3 offset:44864
  s_mul_i32 s90, s83, 24576
  v_mfma_f32_16x16x32_bf16 v[240:243], a[248:251], v[40:43], v[240:243]
  s_add_u32 s90, s90, s85
  s_add_u32 s35, s90, 0
  v_mfma_f32_16x16x32_bf16 v[244:247], a[232:235], v[44:47], v[244:247]
  ds_read_b64_tr_b16 v[60:61], v3 offset:43104
  buffer_load_dwordx4 v28, s[64:67], s35 offen nt lds
  v_mfma_f32_16x16x32_bf16 v[248:251], a[240:243], v[44:47], v[248:251]
  ds_read_b64_tr_b16 v[62:63], v3 offset:44896
  buffer_load_dwordx4 v29, s[64:67], s35 offen offset:1024 nt lds
  v_mfma_f32_16x16x32_bf16 v[252:255], a[248:251], v[44:47], v[252:255]
  s_waitcnt vmcnt(10)
  v_mfma_f32_16x16x32_bf16 v[172:175], a[56:59], v[48:51], v[172:175]
  ds_read_b64_tr_b16 v[40:41], v3 offset:43136
  v_mfma_f32_16x16x32_bf16 v[176:179], a[132:135], v[48:51], v[176:179]
  ds_read_b64_tr_b16 v[42:43], v3 offset:44928
  v_mfma_f32_16x16x32_bf16 v[180:183], a[140:143], v[48:51], v[180:183]
  ds_read_b128 a[204:207], v26 offset:2048
  ds_read_b128 a[104:107], v27 offset:2048
  v_mfma_f32_16x16x32_bf16 v[184:187], a[56:59], v[52:55], v[184:187]
  ds_read_b64_tr_b16 v[44:45], v3 offset:43168
  s_waitcnt lgkmcnt(1)
  v_mfma_f32_16x16x32_bf16 v[188:191], a[132:135], v[52:55], v[188:191]
  ds_read_b64_tr_b16 v[46:47], v3 offset:44960
  s_add_u32 m0, s33, 2048
  v_mfma_f32_16x16x32_bf16 v[192:195], a[140:143], v[52:55], v[192:195]
  s_add_u32 s35, s90, 8192
  v_mfma_f32_16x16x32_bf16 v[196:199], a[56:59], v[56:59], v[196:199]
  ds_read_b64_tr_b16 v[48:49], v3 offset:43200
  buffer_load_dwordx4 v28, s[64:67], s35 offen nt lds
  v_mfma_f32_16x16x32_bf16 v[200:203], a[132:135], v[56:59], v[200:203]
  ds_read_b64_tr_b16 v[50:51], v3 offset:44992
  buffer_load_dwordx4 v29, s[64:67], s35 offen offset:1024 nt lds
  v_mfma_f32_16x16x32_bf16 v[204:207], a[140:143], v[56:59], v[204:207]
  v_mfma_f32_16x16x32_bf16 v[208:211], a[56:59], v[60:63], v[208:211]
  ds_read_b64_tr_b16 v[52:53], v3 offset:50176
  s_waitcnt vmcnt(10)
  v_mfma_f32_16x16x32_bf16 v[212:215], a[132:135], v[60:63], v[212:215]
  ds_read_b64_tr_b16 v[54:55], v3 offset:51968
  v_mfma_f32_16x16x32_bf16 v[216:219], a[140:143], v[60:63], v[216:219]
  s_waitcnt lgkmcnt(4)
  ds_read_b128 a[212:215], v26 offset:4096
  v_mfma_f32_16x16x32_bf16 v[220:223], a[56:59], v[40:43], v[220:223]
  ds_read_b64_tr_b16 v[56:57], v3 offset:50208
  ds_read_b128 a[108:111], v27 offset:4096
  v_mfma_f32_16x16x32_bf16 v[224:227], a[132:135], v[40:43], v[224:227]
  ds_read_b64_tr_b16 v[58:59], v3 offset:52000
  s_waitcnt lgkmcnt(1)
  v_mfma_f32_16x16x32_bf16 v[228:231], a[140:143], v[40:43], v[228:231]
  s_add_u32 m0, s33, 4096
  s_add_u32 s35, s90, 16384
  v_mfma_f32_16x16x32_bf16 v[232:235], a[56:59], v[44:47], v[232:235]
  ds_read_b64_tr_b16 v[60:61], v3 offset:50240
  buffer_load_dwordx4 v28, s[64:67], s35 offen nt lds
  v_mfma_f32_16x16x32_bf16 v[236:239], a[132:135], v[44:47], v[236:239]
  ds_read_b64_tr_b16 v[62:63], v3 offset:52032
  buffer_load_dwordx4 v29, s[64:67], s35 offen offset:1024 nt lds
  v_mfma_f32_16x16x32_bf16 v[240:243], a[140:143], v[44:47], v[240:243]
  v_mfma_f32_16x16x32_bf16 v[244:247], a[56:59], v[48:51], v[244:247]
  ds_read_b64_tr_b16 v[40:41], v3 offset:50272
  v_mfma_f32_16x16x32_bf16 v[248:251], a[132:135], v[48:51], v[248:251]
  ds_read_b64_tr_b16 v[42:43], v3 offset:52064
  s_waitcnt vmcnt(10)
  v_mfma_f32_16x16x32_bf16 v[252:255], a[140:143], v[48:51], v[252:255]
  ds_read_b128 a[112:115], v26 offset:6144
  v_mfma_f32_16x16x32_bf16 v[172:175], a[60:63], v[52:55], v[172:175]
  ds_read_b64_tr_b16 v[44:45], v3 offset:50304
  v_mfma_f32_16x16x32_bf16 v[176:179], a[64:67], v[52:55], v[176:179]
  ds_read_b64_tr_b16 v[46:47], v3 offset:52096
  ds_read_b128 a[116:119], v27 offset:6144
  v_mfma_f32_16x16x32_bf16 v[180:183], a[148:151], v[52:55], v[180:183]
  s_waitcnt lgkmcnt(6)
  s_add_u32 m0, s34, 57344
  v_mfma_f32_16x16x32_bf16 v[184:187], a[60:63], v[56:59], v[184:187]
  ds_read_b64_tr_b16 v[48:49], v3 offset:50336
  s_mul_i32 s91, s83, 229376
  v_mfma_f32_16x16x32_bf16 v[188:191], a[64:67], v[56:59], v[188:191]
  ds_read_b64_tr_b16 v[50:51], v3 offset:52128
  s_add_u32 s91, s91, s88
  v_mfma_f32_16x16x32_bf16 v[192:195], a[148:151], v[56:59], v[192:195]
  buffer_load_dwordx4 v30, s[68:71], s91 offen offset:0 lds
  v_mfma_f32_16x16x32_bf16 v[196:199], a[60:63], v[60:63], v[196:199]
  ds_read_b64_tr_b16 v[52:53], v3 offset:50368
  v_cvt_pk_bf16_f32 v70, v172, v173
  v_mfma_f32_16x16x32_bf16 v[200:203], a[64:67], v[60:63], v[200:203]
  ds_read_b64_tr_b16 v[54:55], v3 offset:52160
  v_cvt_pk_bf16_f32 v71, v174, v175
  v_mfma_f32_16x16x32_bf16 v[204:207], a[148:151], v[60:63], v[204:207]
  s_waitcnt lgkmcnt(5)
  buffer_load_dwordx4 v31, s[68:71], s91 offen offset:1024 lds
  v_mfma_f32_16x16x32_bf16 v[208:211], a[60:63], v[40:43], v[208:211]
  ds_read_b64_tr_b16 v[56:57], v2 offset:0
  v_cvt_pk_bf16_f32 v72, v176, v177
  v_mfma_f32_16x16x32_bf16 v[212:215], a[64:67], v[40:43], v[212:215]
  ds_read_b64_tr_b16 v[58:59], v2 offset:1792
  v_cvt_pk_bf16_f32 v73, v178, v179
  v_mfma_f32_16x16x32_bf16 v[216:219], a[148:151], v[40:43], v[216:219]
  v_cvt_pk_bf16_f32 v74, v180, v181
  v_cvt_pk_bf16_f32 v75, v182, v183
  s_waitcnt vmcnt(10)
  ds_read_b128 a[120:123], v26 offset:8192
  ds_read_b128 a[124:127], v27 offset:8192
  v_mfma_f32_16x16x32_bf16 v[220:223], a[60:63], v[44:47], v[220:223]
  ds_read_b64_tr_b16 v[60:61], v2 offset:32
  v_cvt_pk_bf16_f32 v82, v184, v185
  v_mfma_f32_16x16x32_bf16 v[224:227], a[64:67], v[44:47], v[224:227]
  ds_read_b64_tr_b16 v[62:63], v2 offset:1824
  v_cvt_pk_bf16_f32 v83, v186, v187
  v_mfma_f32_16x16x32_bf16 v[228:231], a[148:151], v[44:47], v[228:231]
  s_waitcnt lgkmcnt(6)
  v_cvt_pk_bf16_f32 v84, v188, v189
  v_mfma_f32_16x16x32_bf16 v[232:235], a[60:63], v[48:51], v[232:235]
  ds_read_b64_tr_b16 v[40:41], v2 offset:64
  v_cvt_pk_bf16_f32 v85, v190, v191
  v_mfma_f32_16x16x32_bf16 v[236:239], a[64:67], v[48:51], v[236:239]
  ds_read_b64_tr_b16 v[42:43], v2 offset:1856
  buffer_load_dwordx4 v32, s[68:71], s91 offen offset:2048 lds
  v_mfma_f32_16x16x32_bf16 v[240:243], a[148:151], v[48:51], v[240:243]
  v_cvt_pk_bf16_f32 v86, v192, v193
  v_cvt_pk_bf16_f32 v87, v194, v195
  v_mfma_f32_16x16x32_bf16 v[244:247], a[60:63], v[52:55], v[244:247]
  ds_read_b64_tr_b16 v[44:45], v2 offset:96
  v_cvt_pk_bf16_f32 v94, v196, v197
  v_cvt_pk_bf16_f32 v95, v198, v199
  v_mfma_f32_16x16x32_bf16 v[248:251], a[64:67], v[52:55], v[248:251]
  ds_read_b64_tr_b16 v[46:47], v2 offset:1888
  v_cvt_pk_bf16_f32 v96, v200, v201
  v_cvt_pk_bf16_f32 v97, v202, v203
  v_mfma_f32_16x16x32_bf16 v[252:255], a[148:151], v[52:55], v[252:255]
  s_waitcnt lgkmcnt(4)
  v_cvt_pk_bf16_f32 v98, v204, v205
  v_cvt_pk_bf16_f32 v99, v206, v207
  buffer_load_dwordx4 v33, s[68:71], s91 offen offset:3072 lds
  v_mfma_f32_16x16x32_bf16 v[172:175], a[68:71], v[56:59], 0
  ds_read_b64_tr_b16 v[48:49], v2 offset:128
  v_cvt_pk_bf16_f32 v106, v208, v209
  v_cvt_pk_bf16_f32 v107, v210, v211
  v_cvt_pk_bf16_f32 v108, v212, v213
  v_cvt_pk_bf16_f32 v109, v214, v215
  v_cvt_pk_bf16_f32 v110, v216, v217
  v_cvt_pk_bf16_f32 v111, v218, v219
  v_cvt_pk_bf16_f32 v118, v220, v221
  v_cvt_pk_bf16_f32 v119, v222, v223
  s_waitcnt vmcnt(10)
  ds_read_b128 a[128:131], v26 offset:10240
  ds_read_b128 a[0:3], v27 offset:10240
  v_mfma_f32_16x16x32_bf16 v[176:179], a[136:139], v[56:59], 0
  ds_read_b64_tr_b16 v[50:51], v2 offset:1920
  s_add_u32 m0, s34, 61440
  v_mfma_f32_16x16x32_bf16 v[180:183], a[144:147], v[56:59], 0
  s_nop 0
  buffer_load_dwordx4 v34, s[68:71], s91 offen offset:0 lds
  v_mfma_f32_16x16x32_bf16 v[184:187], a[68:71], v[60:63], 0
  ds_read_b64_tr_b16 v[52:53], v2 offset:160
  v_cvt_pk_bf16_f32 v120, v224, v225
  v_mfma_f32_16x16x32_bf16 v[188:191], a[136:139], v[60:63], 0
  ds_read_b64_tr_b16 v[54:55], v2 offset:1952
  v_cvt_pk_bf16_f32 v121, v226, v227
  v_mfma_f32_16x16x32_bf16 v[192:195], a[144:147], v[60:63], 0
  s_waitcnt lgkmcnt(6)
  v_cvt_pk_bf16_f32 v122, v228, v229
  v_cvt_pk_bf16_f32 v123, v230, v231
  s_barrier
  v_mfma_f32_16x16x32_bf16 v[196:199], a[68:71], v[40:43], 0
  ds_read_b64_tr_b16 v[56:57], v2 offset:192
  v_cvt_pk_bf16_f32 v130, v232, v233
  v_cvt_pk_bf16_f32 v131, v234, v235
  v_mfma_f32_16x16x32_bf16 v[200:203], a[136:139], v[40:43], 0
  ds_read_b64_tr_b16 v[58:59], v2 offset:1984
  v_cvt_pk_bf16_f32 v132, v236, v237
  v_cvt_pk_bf16_f32 v133, v238, v239
  buffer_load_dwordx4 v35, s[68:71], s91 offen offset:1024 lds
  v_mfma_f32_16x16x32_bf16 v[204:207], a[144:147], v[40:43], 0
  v_cvt_pk_bf16_f32 v134, v240, v241
  v_cvt_pk_bf16_f32 v135, v242, v243
  v_mfma_f32_16x16x32_bf16 v[208:211], a[68:71], v[44:47], 0
  ds_read_b64_tr_b16 v[60:61], v2 offset:7168
  v_cvt_pk_bf16_f32 v142, v244, v245
  v_cvt_pk_bf16_f32 v143, v246, v247
  v_mfma_f32_16x16x32_bf16 v[212:215], a[136:139], v[44:47], 0
  ds_read_b64_tr_b16 v[62:63], v2 offset:8960
  v_cvt_pk_bf16_f32 v144, v248, v249
  v_cvt_pk_bf16_f32 v145, v250, v251
  v_mfma_f32_16x16x32_bf16 v[216:219], a[144:147], v[44:47], 0
  s_waitcnt lgkmcnt(4)
  v_cvt_pk_bf16_f32 v146, v252, v253
  v_cvt_pk_bf16_f32 v147, v254, v255
  buffer_load_dwordx4 v36, s[68:71], s91 offen offset:2048 lds
  v_mfma_f32_16x16x32_bf16 v[220:223], a[68:71], v[48:51], 0
  ds_read_b64_tr_b16 v[40:41], v2 offset:7200
  buffer_load_dword v39, v7, s[16:19], 0 offen sc1
  v_mfma_f32_16x16x32_bf16 v[224:227], a[136:139], v[48:51], 0
  ds_read_b64_tr_b16 v[42:43], v2 offset:8992
  v_mfma_f32_16x16x32_bf16 v[228:231], a[144:147], v[48:51], 0
  v_mfma_f32_16x16x32_bf16 v[232:235], a[68:71], v[52:55], 0
  ds_read_b64_tr_b16 v[44:45], v2 offset:7232
  v_mfma_f32_16x16x32_bf16 v[236:239], a[136:139], v[52:55], 0
  ds_read_b64_tr_b16 v[46:47], v2 offset:9024
  s_waitcnt vmcnt(12)
  v_mfma_f32_16x16x32_bf16 v[240:243], a[144:147], v[52:55], 0
  s_waitcnt lgkmcnt(4)
  ds_read_b128 a[4:7], v26 offset:0
  v_mfma_f32_16x16x32_bf16 v[244:247], a[68:71], v[56:59], 0
  ds_read_b64_tr_b16 v[48:49], v2 offset:7264
  v_mfma_f32_16x16x32_bf16 v[248:251], a[136:139], v[56:59], 0
  ds_read_b64_tr_b16 v[50:51], v2 offset:9056
  ds_read_b128 a[252:255], v27 offset:0
  v_mfma_f32_16x16x32_bf16 v[252:255], a[144:147], v[56:59], 0
  v_mfma_f32_16x16x32_bf16 v[172:175], a[72:75], v[60:63], v[172:175]
  ds_read_b64_tr_b16 v[52:53], v2 offset:7296
  v_mfma_f32_16x16x32_bf16 v[176:179], a[76:79], v[60:63], v[176:179]
  ds_read_b64_tr_b16 v[54:55], v2 offset:9088
  v_mfma_f32_16x16x32_bf16 v[180:183], a[80:83], v[60:63], v[180:183]
  s_waitcnt lgkmcnt(6)
  v_mfma_f32_16x16x32_bf16 v[184:187], a[72:75], v[40:43], v[184:187]
  ds_read_b64_tr_b16 v[56:57], v2 offset:7328
  v_mfma_f32_16x16x32_bf16 v[188:191], a[76:79], v[40:43], v[188:191]
  ds_read_b64_tr_b16 v[58:59], v2 offset:9120
  v_mfma_f32_16x16x32_bf16 v[192:195], a[80:83], v[40:43], v[192:195]
  s_waitcnt vmcnt(10)
  ds_read_b128 a[8:11], v26 offset:2048
  v_mfma_f32_16x16x32_bf16 v[196:199], a[72:75], v[44:47], v[196:199]
  ds_read_b64_tr_b16 v[60:61], v2 offset:7360
  v_mfma_f32_16x16x32_bf16 v[200:203], a[76:79], v[44:47], v[200:203]
  ds_read_b64_tr_b16 v[62:63], v2 offset:9152
  v_mfma_f32_16x16x32_bf16 v[204:207], a[80:83], v[44:47], v[204:207]
  s_waitcnt lgkmcnt(5)
  ds_read_b128 a[16:19], v27 offset:2048
  v_mfma_f32_16x16x32_bf16 v[208:211], a[72:75], v[48:51], v[208:211]
  ds_read_b64_tr_b16 v[40:41], v2 offset:14336
  v_mfma_f32_16x16x32_bf16 v[212:215], a[76:79], v[48:51], v[212:215]
  ds_read_b64_tr_b16 v[42:43], v2 offset:16128
  v_mfma_f32_16x16x32_bf16 v[216:219], a[80:83], v[48:51], v[216:219]
  v_mfma_f32_16x16x32_bf16 v[220:223], a[72:75], v[52:55], v[220:223]
  ds_read_b64_tr_b16 v[44:45], v2 offset:14368
  v_mfma_f32_16x16x32_bf16 v[224:227], a[76:79], v[52:55], v[224:227]
  ds_read_b64_tr_b16 v[46:47], v2 offset:16160
  v_mfma_f32_16x16x32_bf16 v[228:231], a[80:83], v[52:55], v[228:231]
  s_waitcnt lgkmcnt(5)
  v_mfma_f32_16x16x32_bf16 v[232:235], a[72:75], v[56:59], v[232:235]
  ds_read_b64_tr_b16 v[48:49], v2 offset:14400
  s_waitcnt vmcnt(8)
  v_mfma_f32_16x16x32_bf16 v[236:239], a[76:79], v[56:59], v[236:239]
  ds_read_b64_tr_b16 v[50:51], v2 offset:16192
  v_mfma_f32_16x16x32_bf16 v[240:243], a[80:83], v[56:59], v[240:243]
  ds_read_b128 a[24:27], v26 offset:4096
  v_mfma_f32_16x16x32_bf16 v[244:247], a[72:75], v[60:63], v[244:247]
  ds_read_b64_tr_b16 v[52:53], v2 offset:14432
  ds_read_b128 a[12:15], v27 offset:4096
  v_mfma_f32_16x16x32_bf16 v[248:251], a[76:79], v[60:63], v[248:251]
  ds_read_b64_tr_b16 v[54:55], v2 offset:16224
  v_mfma_f32_16x16x32_bf16 v[252:255], a[80:83], v[60:63], v[252:255]
  s_waitcnt lgkmcnt(6)
  v_mfma_f32_16x16x32_bf16 v[172:175], a[172:175], v[40:43], v[172:175]
  ds_read_b64_tr_b16 v[56:57], v2 offset:14464
  v_mfma_f32_16x16x32_bf16 v[176:179], a[168:171], v[40:43], v[176:179]
  ds_read_b64_tr_b16 v[58:59], v2 offset:16256
  v_mfma_f32_16x16x32_bf16 v[180:183], a[88:91], v[40:43], v[180:183]
  v_mfma_f32_16x16x32_bf16 v[184:187], a[172:175], v[44:47], v[184:187]
  ds_read_b64_tr_b16 v[60:61], v2 offset:14496
  s_waitcnt vmcnt(0)
  v_cmp_ne_u32 vcc, s57, v39
  v_mfma_f32_16x16x32_bf16 v[188:191], a[168:171], v[44:47], v[188:191]
  ds_read_b64_tr_b16 v[62:63], v2 offset:16288
  s_cmp_eq_u64 vcc, 0
  v_mfma_f32_16x16x32_bf16 v[192:195], a[88:91], v[44:47], v[192:195]
  s_waitcnt lgkmcnt(4)
  s_cbranch_scc0 Lf1
Lf1_r:
  v_mfma_f32_16x16x32_bf16 v[196:199], a[172:175], v[48:51], v[196:199]
  ds_read_b64_tr_b16 v[40:41], v2 offset:14528
  s_mul_i32 s63, s80, 4608
  v_mfma_f32_16x16x32_bf16 v[200:203], a[168:171], v[48:51], v[200:203]
  ds_read_b64_tr_b16 v[42:43], v2 offset:16320
  buffer_load_dwordx4 a[132:135], v4, s[16:19], s63 offen offset:0 sc1
  v_mfma_f32_16x16x32_bf16 v[204:207], a[88:91], v[48:51], v[204:207]
  buffer_load_dwordx2 a[136:137], v5, s[16:19], s63 offen offset:0 sc1
  v_mfma_f32_16x16x32_bf16 v[208:211], a[172:175], v[52:55], v[208:211]
  ds_read_b64_tr_b16 v[44:45], v2 offset:21504
  v_mfma_f32_16x16x32_bf16 v[212:215], a[168:171], v[52:55], v[212:215]
  ds_read_b64_tr_b16 v[46:47], v2 offset:23296
  v_mfma_f32_16x16x32_bf16 v[216:219], a[88:91], v[52:55], v[216:219]
  s_waitcnt lgkmcnt(4)
  buffer_load_dwordx4 a[144:147], v4, s[16:19], s63 offen offset:1536 sc1
  v_mfma_f32_16x16x32_bf16 v[220:223], a[172:175], v[56:59], v[220:223]
  ds_read_b64_tr_b16 v[48:49], v2 offset:21536
  v_mfma_f32_16x16x32_bf16 v[224:227], a[168:171], v[56:59], v[224:227]
  ds_read_b64_tr_b16 v[50:51], v2 offset:23328
  v_mfma_f32_16x16x32_bf16 v[228:231], a[88:91], v[56:59], v[228:231]
  v_mfma_f32_16x16x32_bf16 v[232:235], a[172:175], v[60:63], v[232:235]
  ds_read_b64_tr_b16 v[52:53], v2 offset:21568
  buffer_load_dwordx2 a[148:149], v5, s[16:19], s63 offen offset:1536 sc1
  v_mfma_f32_16x16x32_bf16 v[236:239], a[168:171], v[60:63], v[236:239]
  ds_read_b64_tr_b16 v[54:55], v2 offset:23360
  v_mfma_f32_16x16x32_bf16 v[240:243], a[88:91], v[60:63], v[240:243]
  s_waitcnt lgkmcnt(4)
  v_mfma_f32_16x16x32_bf16 v[244:247], a[172:175], v[40:43], v[244:247]
  ds_read_b64_tr_b16 v[56:57], v2 offset:21600
  v_mfma_f32_16x16x32_bf16 v[248:251], a[168:171], v[40:43], v[248:251]
  ds_read_b64_tr_b16 v[58:59], v2 offset:23392
  buffer_load_dwordx4 a[156:159], v4, s[16:19], s63 offen offset:3072 sc1
  v_mfma_f32_16x16x32_bf16 v[252:255], a[88:91], v[40:43], v[252:255]
  v_mfma_f32_16x16x32_bf16 v[172:175], a[84:87], v[44:47], v[172:175]
  ds_read_b64_tr_b16 v[60:61], v2 offset:21632
  v_mfma_f32_16x16x32_bf16 v[176:179], a[176:179], v[44:47], v[176:179]
  ds_read_b64_tr_b16 v[62:63], v2 offset:23424
  v_mfma_f32_16x16x32_bf16 v[180:183], a[92:95], v[44:47], v[180:183]
  s_waitcnt lgkmcnt(4)
  buffer_load_dwordx2 a[160:161], v5, s[16:19], s63 offen offset:3072 sc1
  v_mfma_f32_16x16x32_bf16 v[184:187], a[84:87], v[48:51], v[184:187]
  ds_read_b64_tr_b16 v[40:41], v2 offset:21664
  v_mfma_f32_16x16x32_bf16 v[188:191], a[176:179], v[48:51], v[188:191]
  ds_read_b64_tr_b16 v[42:43], v2 offset:23456
  v_mfma_f32_16x16x32_bf16 v[192:195], a[92:95], v[48:51], v[192:195]
  v_mfma_f32_16x16x32_bf16 v[196:199], a[84:87], v[52:55], v[196:199]
  ds_read_b64_tr_b16 v[44:45], v2 offset:21696
  s_mul_i32 s63, s81, 4608
  v_mfma_f32_16x16x32_bf16 v[200:203], a[176:179], v[52:55], v[200:203]
  ds_read_b64_tr_b16 v[46:47], v2 offset:23488
  buffer_load_dwordx4 a[138:141], v4, s[16:19], s63 offen offset:0 sc1
  v_mfma_f32_16x16x32_bf16 v[204:207], a[92:95], v[52:55], v[204:207]
  s_waitcnt lgkmcnt(4)
  v_mfma_f32_16x16x32_bf16 v[208:211], a[84:87], v[56:59], v[208:211]
  ds_read_b64_tr_b16 v[48:49], v2 offset:28672
  v_mfma_f32_16x16x32_bf16 v[212:215], a[176:179], v[56:59], v[212:215]
  ds_read_b64_tr_b16 v[50:51], v2 offset:30464
  buffer_load_dwordx2 a[142:143], v5, s[16:19], s63 offen offset:0 sc1
  v_mfma_f32_16x16x32_bf16 v[216:219], a[92:95], v[56:59], v[216:219]
  v_mfma_f32_16x16x32_bf16 v[220:223], a[84:87], v[60:63], v[220:223]
  ds_read_b64_tr_b16 v[52:53], v2 offset:28704
  v_mfma_f32_16x16x32_bf16 v[224:227], a[176:179], v[60:63], v[224:227]
  ds_read_b64_tr_b16 v[54:55], v2 offset:30496
  v_mfma_f32_16x16x32_bf16 v[228:231], a[92:95], v[60:63], v[228:231]
  s_waitcnt lgkmcnt(4)
  buffer_load_dwordx4 a[150:153], v4, s[16:19], s63 offen offset:1536 sc1
  v_mfma_f32_16x16x32_bf16 v[232:235], a[84:87], v[40:43], v[232:235]
  ds_read_b64_tr_b16 v[56:57], v2 offset:28736
  v_mfma_f32_16x16x32_bf16 v[236:239], a[176:179], v[40:43], v[236:239]
  ds_read_b64_tr_b16 v[58:59], v2 offset:30528
  v_mfma_f32_16x16x32_bf16 v[240:243], a[92:95], v[40:43], v[240:243]
  v_mfma_f32_16x16x32_bf16 v[244:247], a[84:87], v[44:47], v[244:247]
  ds_read_b64_tr_b16 v[60:61], v2 offset:28768
  buffer_load_dwordx2 a[154:155], v5, s[16:19], s63 offen offset:1536 sc1
  v_mfma_f32_16x16x32_bf16 v[248:251], a[176:179], v[44:47], v[248:251]
  ds_read_b64_tr_b16 v[62:63], v2 offset:30560
  v_mfma_f32_16x16x32_bf16 v[252:255], a[92:95], v[44:47], v[252:255]
  s_waitcnt lgkmcnt(4)
  v_mfma_f32_16x16x32_bf16 v[172:175], a[180:183], v[48:51], v[172:175]
  ds_read_b64_tr_b16 v[40:41], v2 offset:28800
  s_barrier
  v_mfma_f32_16x16x32_bf16 v[176:179], a[196:199], v[48:51], v[176:179]
  ds_read_b64_tr_b16 v[42:43], v2 offset:30592
  buffer_load_dwordx4 a[162:165], v4, s[16:19], s63 offen offset:3072 sc1
  v_mfma_f32_16x16x32_bf16 v[180:183], a[184:187], v[48:51], v[180:183]
  v_mfma_f32_16x16x32_bf16 v[184:187], a[180:183], v[52:55], v[184:187]
  ds_read_b64_tr_b16 v[44:45], v2 offset:28832
  v_mfma_f32_16x16x32_bf16 v[188:191], a[196:199], v[52:55], v[188:191]
  ds_read_b64_tr_b16 v[46:47], v2 offset:30624
  v_mfma_f32_16x16x32_bf16 v[192:195], a[184:187], v[52:55], v[192:195]
  s_waitcnt lgkmcnt(4)
  buffer_load_dwordx2 a[166:167], v5, s[16:19], s63 offen offset:3072 sc1
  v_mfma_f32_16x16x32_bf16 v[196:199], a[180:183], v[56:59], v[196:199]
  ds_read_b64_tr_b16 v[48:49], v2 offset:28864
  v_mfma_f32_16x16x32_bf16 v[200:203], a[196:199], v[56:59], v[200:203]
  ds_read_b64_tr_b16 v[50:51], v2 offset:30656
  v_mfma_f32_16x16x32_bf16 v[204:207], a[184:187], v[56:59], v[204:207]
  v_mfma_f32_16x16x32_bf16 v[208:211], a[180:183], v[60:63], v[208:211]
  ds_read_b64_tr_b16 v[52:53], v2 offset:35840
  s_add_u32 m0, s34, 86016
  v_mfma_f32_16x16x32_bf16 v[212:215], a[196:199], v[60:63], v[212:215]
  ds_read_b64_tr_b16 v[54:55], v2 offset:37632
  s_mul_i32 s91, s83, 229376
  v_mfma_f32_16x16x32_bf16 v[216:219], a[184:187], v[60:63], v[216:219]
  s_waitcnt lgkmcnt(4)
  s_add_u32 s91, s91, s89
  v_mfma_f32_16x16x32_bf16 v[220:223], a[180:183], v[40:43], v[220:223]
  ds_read_b64_tr_b16 v[56:57], v2 offset:35872
  buffer_load_dwordx4 v30, s[68:71], s91 offen offset:0 lds
  v_mfma_f32_16x16x32_bf16 v[224:227], a[196:199], v[40:43], v[224:227]
  ds_read_b64_tr_b16 v[58:59], v2 offset:37664
  buffer_load_dwordx4 v31, s[68:71], s91 offen offset:1024 lds
  v_mfma_f32_16x16x32_bf16 v[228:231], a[184:187], v[40:43], v[228:231]
  v_mfma_f32_16x16x32_bf16 v[232:235], a[180:183], v[44:47], v[232:235]
  ds_read_b64_tr_b16 v[60:61], v2 offset:35904
  v_mfma_f32_16x16x32_bf16 v[236:239], a[196:199], v[44:47], v[236:239]
  ds_read_b64_tr_b16 v[62:63], v2 offset:37696
  v_mfma_f32_16x16x32_bf16 v[240:243], a[184:187], v[44:47], v[240:243]
  s_waitcnt lgkmcnt(4)
  buffer_load_dwordx4 v32, s[68:71], s91 offen offset:2048 lds
  v_mfma_f32_16x16x32_bf16 v[244:247], a[180:183], v[48:51], v[244:247]
  ds_read_b64_tr_b16 v[40:41], v2 offset:35936
  v_mfma_f32_16x16x32_bf16 v[248:251], a[196:199], v[48:51], v[248:251]
  ds_read_b64_tr_b16 v[42:43], v2 offset:37728
  v_mfma_f32_16x16x32_bf16 v[252:255], a[184:187], v[48:51], v[252:255]
  v_mfma_f32_16x16x32_bf16 v[172:175], a[188:191], v[52:55], v[172:175]
  ds_read_b64_tr_b16 v[44:45], v2 offset:35968
  buffer_load_dwordx4 v33, s[68:71], s91 offen offset:3072 lds
  v_mfma_f32_16x16x32_bf16 v[176:179], a[96:99], v[52:55], v[176:179]
  ds_read_b64_tr_b16 v[46:47], v2 offset:37760
  v_mfma_f32_16x16x32_bf16 v[180:183], a[192:195], v[52:55], v[180:183]
  s_waitcnt lgkmcnt(4)
  v_mfma_f32_16x16x32_bf16 v[184:187], a[188:191], v[56:59], v[184:187]
  ds_read_b64_tr_b16 v[48:49], v2 offset:36000
  v_mfma_f32_16x16x32_bf16 v[188:191], a[96:99], v[56:59], v[188:191]
  ds_read_b64_tr_b16 v[50:51], v2 offset:37792
  s_add_u32 m0, s34, 90112
  v_mfma_f32_16x16x32_bf16 v[192:195], a[192:195], v[56:59], v[192:195]
  s_nop 0
  buffer_load_dwordx4 v34, s[68:71], s91 offen offset:0 lds
  v_mfma_f32_16x16x32_bf16 v[196:199], a[188:191], v[60:63], v[196:199]
  ds_read_b64_tr_b16 v[52:53], v2 offset:36032
  v_mfma_f32_16x16x32_bf16 v[200:203], a[96:99], v[60:63], v[200:203]
  ds_read_b64_tr_b16 v[54:55], v2 offset:37824
  v_mfma_f32_16x16x32_bf16 v[204:207], a[192:195], v[60:63], v[204:207]
  s_waitcnt lgkmcnt(4)
  buffer_load_dwordx4 v35, s[68:71], s91 offen offset:1024 lds
  v_mfma_f32_16x16x32_bf16 v[208:211], a[188:191], v[40:43], v[208:211]
  ds_read_b64_tr_b16 v[56:57], v2 offset:43008
  v_mfma_f32_16x16x32_bf16 v[212:215], a[96:99], v[40:43], v[212:215]
  ds_read_b64_tr_b16 v[58:59], v2 offset:44800
  v_mfma_f32_16x16x32_bf16 v[216:219], a[192:195], v[40:43], v[216:219]
  v_mfma_f32_16x16x32_bf16 v[220:223], a[188:191], v[44:47], v[220:223]
  ds_read_b64_tr_b16 v[60:61], v2 offset:43040
  buffer_load_dwordx4 v36, s[68:71], s91 offen offset:2048 lds
  v_mfma_f32_16x16x32_bf16 v[224:227], a[96:99], v[44:47], v[224:227]
  ds_read_b64_tr_b16 v[62:63], v2 offset:44832
  v_mfma_f32_16x16x32_bf16 v[228:231], a[192:195], v[44:47], v[228:231]
  s_waitcnt lgkmcnt(4)
  v_mfma_f32_16x16x32_bf16 v[232:235], a[188:191], v[48:51], v[232:235]
  ds_read_b64_tr_b16 v[40:41], v2 offset:43072
  v_mfma_f32_16x16x32_bf16 v[236:239], a[96:99], v[48:51], v[236:239]
  ds_read_b64_tr_b16 v[42:43], v2 offset:44864
  v_mfma_f32_16x16x32_bf16 v[240:243], a[192:195], v[48:51], v[240:243]
  s_add_u32 m0, s33, 6144
  s_mul_i32 s90, s83, 24576
  v_mfma_f32_16x16x32_bf16 v[244:247], a[188:191], v[52:55], v[244:247]
  ds_read_b64_tr_b16 v[44:45], v2 offset:43104
  s_add_u32 s90, s90, s86
  v_mfma_f32_16x16x32_bf16 v[248:251], a[96:99], v[52:55], v[248:251]
  ds_read_b64_tr_b16 v[46:47], v2 offset:44896
  s_add_u32 s35, s90, 0
  v_mfma_f32_16x16x32_bf16 v[252:255], a[192:195], v[52:55], v[252:255]
  s_waitcnt lgkmcnt(4)
  buffer_load_dwordx4 v28, s[64:67], s35 offen nt lds
  v_mfma_f32_16x16x32_bf16 v[172:175], a[200:203], v[56:59], v[172:175]
  ds_read_b64_tr_b16 v[48:49], v2 offset:43136
  buffer_load_dwordx4 v29, s[64:67], s35 offen offset:1024 nt lds
  v_mfma_f32_16x16x32_bf16 v[176:179], a[204:207], v[56:59], v[176:179]
  ds_read_b64_tr_b16 v[50:51], v2 offset:44928
  v_mfma_f32_16x16x32_bf16 v[180:183], a[212:215], v[56:59], v[180:183]
  v_mfma_f32_16x16x32_bf16 v[184:187], a[200:203], v[60:63], v[184:187]
  ds_read_b64_tr_b16 v[52:53], v2 offset:43168
  v_mfma_f32_16x16x32_bf16 v[188:191], a[204:207], v[60:63], v[188:191]
  ds_read_b64_tr_b16 v[54:55], v2 offset:44960
  v_mfma_f32_16x16x32_bf16 v[192:195], a[212:215], v[60:63], v[192:195]
  s_waitcnt lgkmcnt(4)
  v_mfma_f32_16x16x32_bf16 v[196:199], a[200:203], v[40:43], v[196:199]
  ds_read_b64_tr_b16 v[56:57], v2 offset:43200
  s_add_u32 m0, s33, 8192
  v_mfma_f32_16x16x32_bf16 v[200:203], a[204:207], v[40:43], v[200:203]
  ds_read_b64_tr_b16 v[58:59], v2 offset:44992
  s_add_u32 s35, s90, 8192
  v_mfma_f32_16x16x32_bf16 v[204:207], a[212:215], v[40:43], v[204:207]
  buffer_load_dwordx4 v28, s[64:67], s35 offen nt lds
  buffer_load_dwordx4 v29, s[64:67], s35 offen offset:1024 nt lds
  v_mfma_f32_16x16x32_bf16 v[208:211], a[200:203], v[44:47], v[208:211]
  ds_read_b64_tr_b16 v[60:61], v2 offset:50176
  v_mfma_f32_16x16x32_bf16 v[212:215], a[204:207], v[44:47], v[212:215]
  ds_read_b64_tr_b16 v[62:63], v2 offset:51968
  v_mfma_f32_16x16x32_bf16 v[216:219], a[212:215], v[44:47], v[216:219]
  s_waitcnt lgkmcnt(4)
  v_mfma_f32_16x16x32_bf16 v[220:223], a[200:203], v[48:51], v[220:223]
  ds_read_b64_tr_b16 v[40:41], v2 offset:50208
  v_mfma_f32_16x16x32_bf16 v[224:227], a[204:207], v[48:51], v[224:227]
  ds_read_b64_tr_b16 v[42:43], v2 offset:52000
  v_mfma_f32_16x16x32_bf16 v[228:231], a[212:215], v[48:51], v[228:231]
  v_mfma_f32_16x16x32_bf16 v[232:235], a[200:203], v[52:55], v[232:235]
  ds_read_b64_tr_b16 v[44:45], v2 offset:50240
  v_mfma_f32_16x16x32_bf16 v[236:239], a[204:207], v[52:55], v[236:239]
  ds_read_b64_tr_b16 v[46:47], v2 offset:52032
  s_add_u32 m0, s33, 10240
  v_mfma_f32_16x16x32_bf16 v[240:243], a[212:215], v[52:55], v[240:243]
  s_waitcnt lgkmcnt(4)
  s_add_u32 s35, s90, 16384
  v_mfma_f32_16x16x32_bf16 v[244:247], a[200:203], v[56:59], v[244:247]
  ds_read_b64_tr_b16 v[48:49], v2 offset:50272
  buffer_load_dwordx4 v28, s[64:67], s35 offen nt lds
  v_mfma_f32_16x16x32_bf16 v[248:251], a[204:207], v[56:59], v[248:251]
  ds_read_b64_tr_b16 v[50:51], v2 offset:52064
  buffer_load_dwordx4 v29, s[64:67], s35 offen offset:1024 nt lds
  v_mfma_f32_16x16x32_bf16 v[252:255], a[212:215], v[56:59], v[252:255]
  s_waitcnt vmcnt(24)
  v_mfma_f32_16x16x32_bf16 a[168:171], v[64:67], a[132:135], 0
  s_waitcnt vmcnt(22)
  v_mfma_f32_16x16x32_bf16 a[172:175], v[64:67], a[144:147], 0
  s_waitcnt vmcnt(20)
  v_mfma_f32_16x16x32_bf16 a[176:179], v[64:67], a[156:159], 0
  s_waitcnt vmcnt(18)
  v_mfma_f32_16x16x32_bf16 a[168:171], v[68:71], a[136:139], a[168:171]
  s_waitcnt vmcnt(16)
  v_mfma_f32_16x16x32_bf16 a[172:175], v[68:71], a[148:151], a[172:175]
  s_add_u32 m0, s33, 0
  s_waitcnt vmcnt(14)
  v_mfma_f32_16x16x32_bf16 a[176:179], v[68:71], a[160:163], a[176:179]
  s_mul_i32 s90, s83, 24576
  s_add_u32 s90, s90, s87
  v_mfma_f32_16x16x32_bf16 a[168:171], v[72:75], a[140:143], a[168:171]
  s_add_u32 s35, s90, 0
  buffer_load_dwordx4 v28, s[64:67], s35 offen nt lds
  v_mfma_f32_16x16x32_bf16 a[172:175], v[72:75], a[152:155], a[172:175]
  buffer_load_dwordx4 v29, s[64:67], s35 offen offset:1024 nt lds
  s_waitcnt vmcnt(15)
  v_mfma_f32_16x16x32_bf16 a[176:179], v[72:75], a[164:167], a[176:179]
  v_mfma_f32_16x16x32_bf16 a[180:183], v[76:79], a[132:135], 0
  v_mfma_f32_16x16x32_bf16 a[184:187], v[76:79], a[144:147], 0
  v_mfma_f32_16x16x32_bf16 a[188:191], v[76:79], a[156:159], 0
  v_mfma_f32_16x16x32_bf16 a[180:183], v[80:83], a[136:139], a[180:183]
  v_mfma_f32_16x16x32_bf16 a[184:187], v[80:83], a[148:151], a[184:187]
  v_mfma_f32_16x16x32_bf16 a[188:191], v[80:83], a[160:163], a[188:191]
  s_add_u32 m0, s33, 2048
  v_mfma_f32_16x16x32_bf16 a[180:183], v[84:87], a[140:143], a[180:183]
  s_add_u32 s35, s90, 8192
  buffer_load_dwordx4 v28, s[64:67], s35 offen nt lds
  v_mfma_f32_16x16x32_bf16 a[184:187], v[84:87], a[152:155], a[184:187]
  buffer_load_dwordx4 v29, s[64:67], s35 offen offset:1024 nt lds
  v_mfma_f32_16x16x32_bf16 a[188:191], v[84:87], a[164:167], a[188:191]
  v_mfma_f32_16x16x32_bf16 a[192:195], v[88:91], a[132:135], 0
  v_mfma_f32_16x16x32_bf16 a[196:199], v[88:91], a[144:147], 0
  v_mfma_f32_16x16x32_bf16 a[200:203], v[88:91], a[156:159], 0
  v_mfma_f32_16x16x32_bf16 a[192:195], v[92:95], a[136:139], a[192:195]
  v_mfma_f32_16x16x32_bf16 a[196:199], v[92:95], a[148:151], a[196:199]
  v_mfma_f32_16x16x32_bf16 a[200:203], v[92:95], a[160:163], a[200:203]
  v_mfma_f32_16x16x32_bf16 a[192:195], v[96:99], a[140:143], a[192:195]
  s_add_u32 m0, s33, 4096
  v_mfma_f32_16x16x32_bf16 a[196:199], v[96:99], a[152:155], a[196:199]
  s_add_u32 s35, s90, 16384
  buffer_load_dwordx4 v28, s[64:67], s35 offen nt lds
  v_mfma_f32_16x16x32_bf16 a[200:203], v[96:99], a[164:167], a[200:203]
  buffer_load_dwordx4 v29, s[64:67], s35 offen offset:1024 nt lds
  v_mfma_f32_16x16x32_bf16 a[204:207], v[100:103], a[132:135], 0
  v_mfma_f32_16x16x32_bf16 a[208:211], v[100:103], a[144:147], 0
  v_mfma_f32_16x16x32_bf16 a[212:215], v[100:103], a[156:159], 0
  v_mfma_f32_16x16x32_bf16 a[204:207], v[104:107], a[136:139], a[204:207]
  v_mfma_f32_16x16x32_bf16 a[208:211], v[104:107], a[148:151], a[208:211]
  v_mfma_f32_16x16x32_bf16 a[212:215], v[104:107], a[160:163], a[212:215]
  v_mfma_f32_16x16x32_bf16 a[204:207], v[108:111], a[140:143], a[204:207]
  v_mfma_f32_16x16x32_bf16 a[208:211], v[108:111], a[152:155], a[208:211]
  v_mfma_f32_16x16x32_bf16 a[212:215], v[108:111], a[164:167], a[212:215]
  v_mfma_f32_16x16x32_bf16 a[216:219], v[112:115], a[132:135], 0
  v_mfma_f32_16x16x32_bf16 a[220:223], v[112:115], a[144:147], 0
  v_mfma_f32_16x16x32_bf16 a[224:227], v[112:115], a[156:159], 0
  v_mfma_f32_16x16x32_bf16 a[216:219], v[116:119], a[136:139], a[216:219]
  s_waitcnt vmcnt(10)
  ds_read_b128 a[20:23], v26 offset:6144
  v_mfma_f32_16x16x32_bf16 a[220:223], v[116:119], a[148:151], a[220:223]
  ds_read_b128 a[28:31], v27 offset:6144
  v_mfma_f32_16x16x32_bf16 a[224:227], v[116:119], a[160:163], a[224:227]
  v_mfma_f32_16x16x32_bf16 a[216:219], v[120:123], a[140:143], a[216:219]
  v_mfma_f32_16x16x32_bf16 a[220:223], v[120:123], a[152:155], a[220:223]
  v_mfma_f32_16x16x32_bf16 a[224:227], v[120:123], a[164:167], a[224:227]
  v_mfma_f32_16x16x32_bf16 a[228:231], v[124:127], a[132:135], 0
  v_mfma_f32_16x16x32_bf16 a[232:235], v[124:127], a[144:147], 0
  v_mfma_f32_16x16x32_bf16 a[236:239], v[124:127], a[156:159], 0
  v_mfma_f32_16x16x32_bf16 a[228:231], v[128:131], a[136:139], a[228:231]
  v_mfma_f32_16x16x32_bf16 a[232:235], v[128:131], a[148:151], a[232:235]
  s_waitcnt vmcnt(8)
  ds_read_b128 a[32:35], v26 offset:8192
  v_mfma_f32_16x16x32_bf16 a[236:239], v[128:131], a[160:163], a[236:239]
  ds_read_b128 a[40:43], v27 offset:8192
  v_mfma_f32_16x16x32_bf16 a[228:231], v[132:135], a[140:143], a[228:231]
  v_mfma_f32_16x16x32_bf16 a[232:235], v[132:135], a[152:155], a[232:235]
  v_mfma_f32_16x16x32_bf16 a[236:239], v[132:135], a[164:167], a[236:239]
  v_mfma_f32_16x16x32_bf16 a[240:243], v[136:139], a[132:135], 0
  v_mfma_f32_16x16x32_bf16 a[244:247], v[136:139], a[144:147], 0
  v_mfma_f32_16x16x32_bf16 a[248:251], v[136:139], a[156:159], 0
  v_mfma_f32_16x16x32_bf16 a[240:243], v[140:143], a[136:139], a[240:243]
  v_mfma_f32_16x16x32_bf16 a[244:247], v[140:143], a[148:151], a[244:247]
  v_mfma_f32_16x16x32_bf16 a[248:251], v[140:143], a[160:163], a[248:251]
  s_waitcnt vmcnt(6)
  ds_read_b128 a[48:51], v26 offset:10240
  v_mfma_f32_16x16x32_bf16 a[240:243], v[144:147], a[140:143], a[240:243]
  ds_read_b128 a[36:39], v27 offset:10240
  v_mfma_f32_16x16x32_bf16 a[244:247], v[144:147], a[152:155], a[244:247]
  v_mfma_f32_16x16x32_bf16 a[248:251], v[144:147], a[164:167], a[248:251]
  v_mfma_f32_16x16x32_bf16 v[172:175], a[100:103], v[60:63], v[172:175]
  ds_read_b64_tr_b16 v[52:53], v2 offset:50304
  s_mul_i32 s63, s82, 4608
  v_mfma_f32_16x16x32_bf16 v[176:179], a[104:107], v[60:63], v[176:179]
  ds_read_b64_tr_b16 v[54:55], v2 offset:52096
  buffer_load_dwordx4 a[132:135], v4, s[16:19], s63 offen offset:0 sc1
  v_mfma_f32_16x16x32_bf16 v[180:183], a[108:111], v[60:63], v[180:183]
  s_waitcnt lgkmcnt(10)
  v_mfma_f32_16x16x32_bf16 v[184:187], a[100:103], v[40:43], v[184:187]
  ds_read_b64_tr_b16 v[56:57], v2 offset:50336
  v_mfma_f32_16x16x32_bf16 v[188:191], a[104:107], v[40:43], v[188:191]
  ds_read_b64_tr_b16 v[58:59], v2 offset:52128
  buffer_load_dwordx2 a[136:137], v5, s[16:19], s63 offen offset:0 sc1
  v_mfma_f32_16x16x32_bf16 v[192:195], a[108:111], v[40:43], v[192:195]
  v_mfma_f32_16x16x32_bf16 v[196:199], a[100:103], v[44:47], v[196:199]
  ds_read_b64_tr_b16 v[60:61], v2 offset:50368
  v_cvt_pk_bf16_f32 v64, v172, v173
  v_mfma_f32_16x16x32_bf16 v[200:203], a[104:107], v[44:47], v[200:203]
  ds_read_b64_tr_b16 v[62:63], v2 offset:52160
  v_cvt_pk_bf16_f32 v65, v174, v175
  v_mfma_f32_16x16x32_bf16 v[204:207], a[108:111], v[44:47], v[204:207]
  s_waitcnt lgkmcnt(4)
  s_waitcnt vmcnt(6)
  v_mfma_f32_16x16x32_bf16 v[208:211], a[100:103], v[48:51], v[208:211]
  ds_read_b64_tr_b16 v[40:41], v3 offset:0
  ds_read_b128 a[44:47], v26 offset:0
  ds_read_b128 a[52:55], v27 offset:0
  v_mfma_f32_16x16x32_bf16 v[212:215], a[104:107], v[48:51], v[212:215]
  ds_read_b64_tr_b16 v[42:43], v3 offset:1792
  v_cvt_pk_bf16_f32 v66, v176, v177
  v_mfma_f32_16x16x32_bf16 v[216:219], a[108:111], v[48:51], v[216:219]
  v_cvt_pk_bf16_f32 v67, v178, v179
  v_cvt_pk_bf16_f32 v68, v180, v181
  v_mfma_f32_16x16x32_bf16 v[220:223], a[100:103], v[52:55], v[220:223]
  ds_read_b64_tr_b16 v[44:45], v3 offset:32
  v_cvt_pk_bf16_f32 v69, v182, v183
  v_mfma_f32_16x16x32_bf16 v[224:227], a[104:107], v[52:55], v[224:227]
  ds_read_b64_tr_b16 v[46:47], v3 offset:1824
  buffer_load_dwordx4 a[144:147], v4, s[16:19], s63 offen offset:1536 sc1
  v_mfma_f32_16x16x32_bf16 v[228:231], a[108:111], v[52:55], v[228:231]
  s_waitcnt lgkmcnt(6)
  v_cvt_pk_bf16_f32 v76, v184, v185
  v_mfma_f32_16x16x32_bf16 v[232:235], a[100:103], v[56:59], v[232:235]
  ds_read_b64_tr_b16 v[48:49], v3 offset:64
  v_cvt_pk_bf16_f32 v77, v186, v187
  v_mfma_f32_16x16x32_bf16 v[236:239], a[104:107], v[56:59], v[236:239]
  ds_read_b64_tr_b16 v[50:51], v3 offset:1856
  v_cvt_pk_bf16_f32 v78, v188, v189
  v_cvt_pk_bf16_f32 v79, v190, v191
  v_mfma_f32_16x16x32_bf16 v[240:243], a[108:111], v[56:59], v[240:243]
  v_cvt_pk_bf16_f32 v80, v192, v193
  v_cvt_pk_bf16_f32 v81, v194, v195
  v_mfma_f32_16x16x32_bf16 v[244:247], a[100:103], v[60:63], v[244:247]
  ds_read_b64_tr_b16 v[52:53], v3 offset:96
  v_cvt_pk_bf16_f32 v88, v196, v197
  v_cvt_pk_bf16_f32 v89, v198, v199
  buffer_load_dwordx2 a[148:149], v5, s[16:19], s63 offen offset:1536 sc1
  v_mfma_f32_16x16x32_bf16 v[248:251], a[104:107], v[60:63], v[248:251]
  ds_read_b64_tr_b16 v[54:55], v3 offset:1888
  v_cvt_pk_bf16_f32 v90, v200, v201
  v_cvt_pk_bf16_f32 v91, v202, v203
  v_cvt_pk_bf16_f32 v92, v204, v205
  v_cvt_pk_bf16_f32 v93, v206, v207
  v_cvt_pk_bf16_f32 v100, v208, v209
  v_cvt_pk_bf16_f32 v101, v210, v211
  v_cvt_pk_bf16_f32 v102, v212, v213
  v_cvt_pk_bf16_f32 v103, v214, v215
  s_waitcnt vmcnt(6)
  ds_read_b128 a[56:59], v26 offset:2048
  ds_read_b128 a[60:63], v27 offset:2048
  v_mfma_f32_16x16x32_bf16 v[252:255], a[108:111], v[60:63], v[252:255]
  s_waitcnt lgkmcnt(6)
  buffer_load_dwordx4 a[156:159], v4, s[16:19], s63 offen offset:3072 sc1
  v_mfma_f32_16x16x32_bf16 v[172:175], a[112:115], v[40:43], 0
  ds_read_b64_tr_b16 v[56:57], v3 offset:128
  v_cvt_pk_bf16_f32 v104, v216, v217
  v_mfma_f32_16x16x32_bf16 v[176:179], a[120:123], v[40:43], 0
  ds_read_b64_tr_b16 v[58:59], v3 offset:1920
  v_cvt_pk_bf16_f32 v105, v218, v219
  v_mfma_f32_16x16x32_bf16 v[180:183], a[128:131], v[40:43], 0
  v_cvt_pk_bf16_f32 v112, v220, v221
  v_cvt_pk_bf16_f32 v113, v222, v223
  v_mfma_f32_16x16x32_bf16 v[184:187], a[112:115], v[44:47], 0
  ds_read_b64_tr_b16 v[60:61], v3 offset:160
  v_cvt_pk_bf16_f32 v114, v224, v225
  v_mfma_f32_16x16x32_bf16 v[188:191], a[120:123], v[44:47], 0
  ds_read_b64_tr_b16 v[62:63], v3 offset:1952
  v_cvt_pk_bf16_f32 v115, v226, v227
  v_mfma_f32_16x16x32_bf16 v[192:195], a[128:131], v[44:47], 0
  s_waitcnt lgkmcnt(6)
  v_cvt_pk_bf16_f32 v116, v228, v229
  v_cvt_pk_bf16_f32 v117, v230, v231
  s_barrier
  buffer_load_dwordx2 a[160:161], v5, s[16:19], s63 offen offset:3072 sc1
  v_mfma_f32_16x16x32_bf16 v[196:199], a[112:115], v[48:51], 0
  ds_read_b64_tr_b16 v[40:41], v3 offset:192
  v_cvt_pk_bf16_f32 v124, v232, v233
  v_cvt_pk_bf16_f32 v125, v234, v235
  v_mfma_f32_16x16x32_bf16 v[200:203], a[120:123], v[48:51], 0
  ds_read_b64_tr_b16 v[42:43], v3 offset:1984
  v_cvt_pk_bf16_f32 v126, v236, v237
  v_cvt_pk_bf16_f32 v127, v238, v239
  v_mfma_f32_16x16x32_bf16 v[204:207], a[128:131], v[48:51], 0
  v_cvt_pk_bf16_f32 v128, v240, v241
  v_cvt_pk_bf16_f32 v129, v242, v243
  v_cvt_pk_bf16_f32 v136, v244, v245
  v_cvt_pk_bf16_f32 v137, v246, v247
  s_mul_i32 s63, s83, 4608
  buffer_load_dwordx4 a[138:141], v4, s[16:19], s63 offen offset:0 sc1
  v_cvt_pk_bf16_f32 v138, v248, v249
  v_cvt_pk_bf16_f32 v139, v250, v251
  v_cvt_pk_bf16_f32 v140, v252, v253
  v_cvt_pk_bf16_f32 v141, v254, v255
  s_waitcnt vmcnt(7)
  ds_read_b128 a[64:67], v26 offset:4096
  ds_read_b128 a[68:71], v27 offset:4096
  v_mfma_f32_16x16x32_bf16 v[208:211], a[112:115], v[52:55], 0
  ds_read_b64_tr_b16 v[44:45], v3 offset:7168
  buffer_load_dwordx2 a[142:143], v5, s[16:19], s63 offen offset:0 sc1
  v_mfma_f32_16x16x32_bf16 v[212:215], a[120:123], v[52:55], 0
  ds_read_b64_tr_b16 v[46:47], v3 offset:8960
  v_mfma_f32_16x16x32_bf16 v[216:219], a[128:131], v[52:55], 0
  s_waitcnt lgkmcnt(6)
  buffer_load_dwordx4 a[150:153], v4, s[16:19], s63 offen offset:1536 sc1
  v_mfma_f32_16x16x32_bf16 v[220:223], a[112:115], v[56:59], 0
  ds_read_b64_tr_b16 v[48:49], v3 offset:7200
  v_mfma_f32_16x16x32_bf16 v[224:227], a[120:123], v[56:59], 0
  ds_read_b64_tr_b16 v[50:51], v3 offset:8992
  v_mfma_f32_16x16x32_bf16 v[228:231], a[128:131], v[56:59], 0
  v_mfma_f32_16x16x32_bf16 v[232:235], a[112:115], v[60:63], 0
  ds_read_b64_tr_b16 v[52:53], v3 offset:7232
  buffer_load_dwordx2 a[154:155], v5, s[16:19], s63 offen offset:1536 sc1
  v_mfma_f32_16x16x32_bf16 v[236:239], a[120:123], v[60:63], 0
  ds_read_b64_tr_b16 v[54:55], v3 offset:9024
  v_mfma_f32_16x16x32_bf16 v[240:243], a[128:131], v[60:63], 0
  s_waitcnt lgkmcnt(4)
  v_mfma_f32_16x16x32_bf16 v[244:247], a[112:115], v[40:43], 0
  ds_read_b64_tr_b16 v[56:57], v3 offset:7264
  v_mfma_f32_16x16x32_bf16 v[248:251], a[120:123], v[40:43], 0
  ds_read_b64_tr_b16 v[58:59], v3 offset:9056
  buffer_load_dwordx4 a[162:165], v4, s[16:19], s63 offen offset:3072 sc1
  v_mfma_f32_16x16x32_bf16 v[252:255], a[128:131], v[40:43], 0
  v_mfma_f32_16x16x32_bf16 v[172:175], a[116:119], v[44:47], v[172:175]
  ds_read_b64_tr_b16 v[60:61], v3 offset:7296
  v_mfma_f32_16x16x32_bf16 v[176:179], a[124:127], v[44:47], v[176:179]
  ds_read_b64_tr_b16 v[62:63], v3 offset:9088
  v_mfma_f32_16x16x32_bf16 v[180:183], a[0:3], v[44:47], v[180:183]
  s_waitcnt lgkmcnt(4)
  buffer_load_dwordx2 a[166:167], v5, s[16:19], s63 offen offset:3072 sc1
  v_mfma_f32_16x16x32_bf16 v[184:187], a[116:119], v[48:51], v[184:187]
  ds_read_b64_tr_b16 v[40:41], v3 offset:7328
  v_mfma_f32_16x16x32_bf16 v[188:191], a[124:127], v[48:51], v[188:191]
  ds_read_b64_tr_b16 v[42:43], v3 offset:9120
  v_mfma_f32_16x16x32_bf16 v[192:195], a[0:3], v[48:51], v[192:195]
  v_mfma_f32_16x16x32_bf16 v[196:199], a[116:119], v[52:55], v[196:199]
  ds_read_b64_tr_b16 v[44:45], v3 offset:7360
  v_mfma_f32_16x16x32_bf16 v[200:203], a[124:127], v[52:55], v[200:203]
  ds_read_b64_tr_b16 v[46:47], v3 offset:9152
  v_mfma_f32_16x16x32_bf16 v[204:207], a[0:3], v[52:55], v[204:207]
  s_waitcnt lgkmcnt(4)
  v_mfma_f32_16x16x32_bf16 v[208:211], a[116:119], v[56:59], v[208:211]
  ds_read_b64_tr_b16 v[48:49], v3 offset:14336
  v_mfma_f32_16x16x32_bf16 v[212:215], a[124:127], v[56:59], v[212:215]
  ds_read_b64_tr_b16 v[50:51], v3 offset:16128
  v_mfma_f32_16x16x32_bf16 v[216:219], a[0:3], v[56:59], v[216:219]
  v_mfma_f32_16x16x32_bf16 v[220:223], a[116:119], v[60:63], v[220:223]
  ds_read_b64_tr_b16 v[52:53], v3 offset:14368
  v_mfma_f32_16x16x32_bf16 v[224:227], a[124:127], v[60:63], v[224:227]
  ds_read_b64_tr_b16 v[54:55], v3 offset:16160
  v_mfma_f32_16x16x32_bf16 v[228:231], a[0:3], v[60:63], v[228:231]
  s_waitcnt lgkmcnt(4)
  v_mfma_f32_16x16x32_bf16 v[232:235], a[116:119], v[40:43], v[232:235]
  ds_read_b64_tr_b16 v[56:57], v3 offset:14400
  v_mfma_f32_16x16x32_bf16 v[236:239], a[124:127], v[40:43], v[236:239]
  ds_read_b64_tr_b16 v[58:59], v3 offset:16192
  v_mfma_f32_16x16x32_bf16 v[240:243], a[0:3], v[40:43], v[240:243]
  v_mfma_f32_16x16x32_bf16 v[244:247], a[116:119], v[44:47], v[244:247]
  ds_read_b64_tr_b16 v[60:61], v3 offset:14432
  v_mfma_f32_16x16x32_bf16 v[248:251], a[124:127], v[44:47], v[248:251]
  ds_read_b64_tr_b16 v[62:63], v3 offset:16224
  v_mfma_f32_16x16x32_bf16 v[252:255], a[0:3], v[44:47], v[252:255]
  s_waitcnt lgkmcnt(4)
  v_mfma_f32_16x16x32_bf16 v[172:175], a[4:7], v[48:51], v[172:175]
  ds_read_b64_tr_b16 v[40:41], v3 offset:14464
  v_mfma_f32_16x16x32_bf16 v[176:179], a[8:11], v[48:51], v[176:179]
  ds_read_b64_tr_b16 v[42:43], v3 offset:16256
  v_mfma_f32_16x16x32_bf16 v[180:183], a[24:27], v[48:51], v[180:183]
  v_mfma_f32_16x16x32_bf16 v[184:187], a[4:7], v[52:55], v[184:187]
  ds_read_b64_tr_b16 v[44:45], v3 offset:14496
  v_mfma_f32_16x16x32_bf16 v[188:191], a[8:11], v[52:55], v[188:191]
  ds_read_b64_tr_b16 v[46:47], v3 offset:16288
  v_mfma_f32_16x16x32_bf16 v[192:195], a[24:27], v[52:55], v[192:195]
  s_waitcnt lgkmcnt(4)
  v_mfma_f32_16x16x32_bf16 v[196:199], a[4:7], v[56:59], v[196:199]
  ds_read_b64_tr_b16 v[48:49], v3 offset:14528
  v_mfma_f32_16x16x32_bf16 v[200:203], a[8:11], v[56:59], v[200:203]
  ds_read_b64_tr_b16 v[50:51], v3 offset:16320
  v_mfma_f32_16x16x32_bf16 v[204:207], a[24:27], v[56:59], v[204:207]
  v_mfma_f32_16x16x32_bf16 v[208:211], a[4:7], v[60:63], v[208:211]
  ds_read_b64_tr_b16 v[52:53], v3 offset:21504
  v_mfma_f32_16x16x32_bf16 v[212:215], a[8:11], v[60:63], v[212:215]
  ds_read_b64_tr_b16 v[54:55], v3 offset:23296
  v_mfma_f32_16x16x32_bf16 v[216:219], a[24:27], v[60:63], v[216:219]
  s_waitcnt lgkmcnt(4)
  v_mfma_f32_16x16x32_bf16 v[220:223], a[4:7], v[40:43], v[220:223]
  ds_read_b64_tr_b16 v[56:57], v3 offset:21536
  v_mfma_f32_16x16x32_bf16 v[224:227], a[8:11], v[40:43], v[224:227]
  ds_read_b64_tr_b16 v[58:59], v3 offset:23328
  v_mfma_f32_16x16x32_bf16 v[228:231], a[24:27], v[40:43], v[228:231]
  v_mfma_f32_16x16x32_bf16 v[232:235], a[4:7], v[44:47], v[232:235]
  ds_read_b64_tr_b16 v[60:61], v3 offset:21568
  v_mfma_f32_16x16x32_bf16 v[236:239], a[8:11], v[44:47], v[236:239]
  ds_read_b64_tr_b16 v[62:63], v3 offset:23360
  v_mfma_f32_16x16x32_bf16 v[240:243], a[24:27], v[44:47], v[240:243]
  s_waitcnt lgkmcnt(4)
  v_mfma_f32_16x16x32_bf16 v[244:247], a[4:7], v[48:51], v[244:247]
  ds_read_b64_tr_b16 v[40:41], v3 offset:21600
  v_mfma_f32_16x16x32_bf16 v[248:251], a[8:11], v[48:51], v[248:251]
  ds_read_b64_tr_b16 v[42:43], v3 offset:23392
  v_mfma_f32_16x16x32_bf16 v[252:255], a[24:27], v[48:51], v[252:255]
  v_mfma_f32_16x16x32_bf16 v[172:175], a[252:255], v[52:55], v[172:175]
  ds_read_b64_tr_b16 v[44:45], v3 offset:21632
  v_mfma_f32_16x16x32_bf16 v[176:179], a[16:19], v[52:55], v[176:179]
  ds_read_b64_tr_b16 v[46:47], v3 offset:23424
  v_mfma_f32_16x16x32_bf16 v[180:183], a[12:15], v[52:55], v[180:183]
  s_waitcnt lgkmcnt(4)
  v_mfma_f32_16x16x32_bf16 v[184:187], a[252:255], v[56:59], v[184:187]
  ds_read_b64_tr_b16 v[48:49], v3 offset:21664
  v_mfma_f32_16x16x32_bf16 v[188:191], a[16:19], v[56:59], v[188:191]
  ds_read_b64_tr_b16 v[50:51], v3 offset:23456
  v_mfma_f32_16x16x32_bf16 v[192:195], a[12:15], v[56:59], v[192:195]
  v_mfma_f32_16x16x32_bf16 v[196:199], a[252:255], v[60:63], v[196:199]
  ds_read_b64_tr_b16 v[52:53], v3 offset:21696
  v_mfma_f32_16x16x32_bf16 v[200:203], a[16:19], v[60:63], v[200:203]
  ds_read_b64_tr_b16 v[54:55], v3 offset:23488
  v_mfma_f32_16x16x32_bf16 v[204:207], a[12:15], v[60:63], v[204:207]
  s_waitcnt lgkmcnt(4)
  v_mfma_f32_16x16x32_bf16 v[208:211], a[252:255], v[40:43], v[208:211]
  ds_read_b64_tr_b16 v[56:57], v3 offset:28672
  v_mfma_f32_16x16x32_bf16 v[212:215], a[16:19], v[40:43], v[212:215]
  ds_read_b64_tr_b16 v[58:59], v3 offset:30464
  v_mfma_f32_16x16x32_bf16 v[216:219], a[12:15], v[40:43], v[216:219]
  v_mfma_f32_16x16x32_bf16 v[220:223], a[252:255], v[44:47], v[220:223]
  ds_read_b64_tr_b16 v[60:61], v3 offset:28704
  v_mfma_f32_16x16x32_bf16 v[224:227], a[16:19], v[44:47], v[224:227]
  ds_read_b64_tr_b16 v[62:63], v3 offset:30496
  v_mfma_f32_16x16x32_bf16 v[228:231], a[12:15], v[44:47], v[228:231]
  s_waitcnt lgkmcnt(4)
  v_mfma_f32_16x16x32_bf16 v[232:235], a[252:255], v[48:51], v[232:235]
  ds_read_b64_tr_b16 v[40:41], v3 offset:28736
  v_mfma_f32_16x16x32_bf16 v[236:239], a[16:19], v[48:51], v[236:239]
  ds_read_b64_tr_b16 v[42:43], v3 offset:30528
  v_mfma_f32_16x16x32_bf16 v[240:243], a[12:15], v[48:51], v[240:243]
  v_mfma_f32_16x16x32_bf16 v[244:247], a[252:255], v[52:55], v[244:247]
  ds_read_b64_tr_b16 v[44:45], v3 offset:28768
  v_mfma_f32_16x16x32_bf16 v[248:251], a[16:19], v[52:55], v[248:251]
  ds_read_b64_tr_b16 v[46:47], v3 offset:30560
  v_mfma_f32_16x16x32_bf16 v[252:255], a[12:15], v[52:55], v[252:255]
  s_waitcnt lgkmcnt(4)
  v_mfma_f32_16x16x32_bf16 v[172:175], a[20:23], v[56:59], v[172:175]
  ds_read_b64_tr_b16 v[48:49], v3 offset:28800
  v_mfma_f32_16x16x32_bf16 v[176:179], a[32:35], v[56:59], v[176:179]
  ds_read_b64_tr_b16 v[50:51], v3 offset:30592
  v_mfma_f32_16x16x32_bf16 v[180:183], a[48:51], v[56:59], v[180:183]
  v_mfma_f32_16x16x32_bf16 v[184:187], a[20:23], v[60:63], v[184:187]
  ds_read_b64_tr_b16 v[52:53], v3 offset:28832
  v_mfma_f32_16x16x32_bf16 v[188:191], a[32:35], v[60:63], v[188:191]
  ds_read_b64_tr_b16 v[54:55], v3 offset:30624
  v_mfma_f32_16x16x32_bf16 v[192:195], a[48:51], v[60:63], v[192:195]
  s_waitcnt lgkmcnt(4)
  v_mfma_f32_16x16x32_bf16 v[196:199], a[20:23], v[40:43], v[196:199]
  ds_read_b64_tr_b16 v[56:57], v3 offset:28864
  v_mfma_f32_16x16x32_bf16 v[200:203], a[32:35], v[40:43], v[200:203]
  ds_read_b64_tr_b16 v[58:59], v3 offset:30656
  v_mfma_f32_16x16x32_bf16 v[204:207], a[48:51], v[40:43], v[204:207]
  v_mfma_f32_16x16x32_bf16 v[208:211], a[20:23], v[44:47], v[208:211]
  ds_read_b64_tr_b16 v[60:61], v3 offset:35840
  v_mfma_f32_16x16x32_bf16 v[212:215], a[32:35], v[44:47], v[212:215]
  ds_read_b64_tr_b16 v[62:63], v3 offset:37632
  v_mfma_f32_16x16x32_bf16 v[216:219], a[48:51], v[44:47], v[216:219]
  s_waitcnt lgkmcnt(4)
  v_mfma_f32_16x16x32_bf16 v[220:223], a[20:23], v[48:51], v[220:223]
  ds_read_b64_tr_b16 v[40:41], v3 offset:35872
  v_mfma_f32_16x16x32_bf16 v[224:227], a[32:35], v[48:51], v[224:227]
  ds_read_b64_tr_b16 v[42:43], v3 offset:37664
  v_mfma_f32_16x16x32_bf16 v[228:231], a[48:51], v[48:51], v[228:231]
  v_mfma_f32_16x16x32_bf16 v[232:235], a[20:23], v[52:55], v[232:235]
  ds_read_b64_tr_b16 v[44:45], v3 offset:35904
  v_mfma_f32_16x16x32_bf16 v[236:239], a[32:35], v[52:55], v[236:239]
  ds_read_b64_tr_b16 v[46:47], v3 offset:37696
  v_mfma_f32_16x16x32_bf16 v[240:243], a[48:51], v[52:55], v[240:243]
  s_waitcnt lgkmcnt(4)
  v_mfma_f32_16x16x32_bf16 v[244:247], a[20:23], v[56:59], v[244:247]
  ds_read_b64_tr_b16 v[48:49], v3 offset:35936
  v_mfma_f32_16x16x32_bf16 v[248:251], a[32:35], v[56:59], v[248:251]
  ds_read_b64_tr_b16 v[50:51], v3 offset:37728
  v_mfma_f32_16x16x32_bf16 v[252:255], a[48:51], v[56:59], v[252:255]
  v_mfma_f32_16x16x32_bf16 v[172:175], a[28:31], v[60:63], v[172:175]
  ds_read_b64_tr_b16 v[52:53], v3 offset:35968
  v_mfma_f32_16x16x32_bf16 v[176:179], a[40:43], v[60:63], v[176:179]
  ds_read_b64_tr_b16 v[54:55], v3 offset:37760
  v_mfma_f32_16x16x32_bf16 v[180:183], a[36:39], v[60:63], v[180:183]
  s_waitcnt lgkmcnt(4)
  v_mfma_f32_16x16x32_bf16 v[184:187], a[28:31], v[40:43], v[184:187]
  ds_read_b64_tr_b16 v[56:57], v3 offset:36000
  v_mfma_f32_16x16x32_bf16 v[188:191], a[40:43], v[40:43], v[188:191]
  ds_read_b64_tr_b16 v[58:59], v3 offset:37792
  v_mfma_f32_16x16x32_bf16 v[192:195], a[36:39], v[40:43], v[192:195]
  v_mfma_f32_16x16x32_bf16 v[196:199], a[28:31], v[44:47], v[196:199]
  ds_read_b64_tr_b16 v[60:61], v3 offset:36032
  v_mfma_f32_16x16x32_bf16 v[200:203], a[40:43], v[44:47], v[200:203]
  ds_read_b64_tr_b16 v[62:63], v3 offset:37824
  v_mfma_f32_16x16x32_bf16 v[204:207], a[36:39], v[44:47], v[204:207]
  s_waitcnt lgkmcnt(4)
  v_mfma_f32_16x16x32_bf16 v[208:211], a[28:31], v[48:51], v[208:211]
  ds_read_b64_tr_b16 v[40:41], v3 offset:43008
  v_mfma_f32_16x16x32_bf16 v[212:215], a[40:43], v[48:51], v[212:215]
  ds_read_b64_tr_b16 v[42:43], v3 offset:44800
  v_mfma_f32_16x16x32_bf16 v[216:219], a[36:39], v[48:51], v[216:219]
  v_mfma_f32_16x16x32_bf16 v[220:223], a[28:31], v[52:55], v[220:223]
  ds_read_b64_tr_b16 v[44:45], v3 offset:43040
  v_mfma_f32_16x16x32_bf16 v[224:227], a[40:43], v[52:55], v[224:227]
  ds_read_b64_tr_b16 v[46:47], v3 offset:44832
  v_mfma_f32_16x16x32_bf16 v[228:231], a[36:39], v[52:55], v[228:231]
  s_waitcnt lgkmcnt(4)
  v_mfma_f32_16x16x32_bf16 v[232:235], a[28:31], v[56:59], v[232:235]
  ds_read_b64_tr_b16 v[48:49], v3 offset:43072
  v_mfma_f32_16x16x32_bf16 v[236:239], a[40:43], v[56:59], v[236:239]
  ds_read_b64_tr_b16 v[50:51], v3 offset:44864
  v_mfma_f32_16x16x32_bf16 v[240:243], a[36:39], v[56:59], v[240:243]
  v_mfma_f32_16x16x32_bf16 v[244:247], a[28:31], v[60:63], v[244:247]
  ds_read_b64_tr_b16 v[52:53], v3 offset:43104
  v_mfma_f32_16x16x32_bf16 v[248:251], a[40:43], v[60:63], v[248:251]
  ds_read_b64_tr_b16 v[54:55], v3 offset:44896
  v_mfma_f32_16x16x32_bf16 v[252:255], a[36:39], v[60:63], v[252:255]
  s_waitcnt lgkmcnt(4)
  v_mfma_f32_16x16x32_bf16 v[172:175], a[44:47], v[40:43], v[172:175]
  ds_read_b64_tr_b16 v[56:57], v3 offset:43136
  v_mfma_f32_16x16x32_bf16 v[176:179], a[56:59], v[40:43], v[176:179]
  ds_read_b64_tr_b16 v[58:59], v3 offset:44928
  v_mfma_f32_16x16x32_bf16 v[180:183], a[64:67], v[40:43], v[180:183]
  v_mfma_f32_16x16x32_bf16 v[184:187], a[44:47], v[44:47], v[184:187]
  ds_read_b64_tr_b16 v[60:61], v3 offset:43168
  v_mfma_f32_16x16x32_bf16 v[188:191], a[56:59], v[44:47], v[188:191]
  ds_read_b64_tr_b16 v[62:63], v3 offset:44960
  v_mfma_f32_16x16x32_bf16 v[192:195], a[64:67], v[44:47], v[192:195]
  s_waitcnt lgkmcnt(4)
  v_mfma_f32_16x16x32_bf16 v[196:199], a[44:47], v[48:51], v[196:199]
  ds_read_b64_tr_b16 v[40:41], v3 offset:43200
  v_mfma_f32_16x16x32_bf16 v[200:203], a[56:59], v[48:51], v[200:203]
  ds_read_b64_tr_b16 v[42:43], v3 offset:44992
  v_mfma_f32_16x16x32_bf16 v[204:207], a[64:67], v[48:51], v[204:207]
  v_mfma_f32_16x16x32_bf16 v[208:211], a[44:47], v[52:55], v[208:211]
  ds_read_b64_tr_b16 v[44:45], v3 offset:50176
  v_mfma_f32_16x16x32_bf16 v[212:215], a[56:59], v[52:55], v[212:215]
  ds_read_b64_tr_b16 v[46:47], v3 offset:51968
  v_mfma_f32_16x16x32_bf16 v[216:219], a[64:67], v[52:55], v[216:219]
  s_waitcnt lgkmcnt(4)
  v_mfma_f32_16x16x32_bf16 v[220:223], a[44:47], v[56:59], v[220:223]
  ds_read_b64_tr_b16 v[48:49], v3 offset:50208
  v_mfma_f32_16x16x32_bf16 v[224:227], a[56:59], v[56:59], v[224:227]
  ds_read_b64_tr_b16 v[50:51], v3 offset:52000
  v_mfma_f32_16x16x32_bf16 v[228:231], a[64:67], v[56:59], v[228:231]
  v_mfma_f32_16x16x32_bf16 v[232:235], a[44:47], v[60:63], v[232:235]
  ds_read_b64_tr_b16 v[52:53], v3 offset:50240
  v_mfma_f32_16x16x32_bf16 v[236:239], a[56:59], v[60:63], v[236:239]
  ds_read_b64_tr_b16 v[54:55], v3 offset:52032
  v_mfma_f32_16x16x32_bf16 v[240:243], a[64:67], v[60:63], v[240:243]
  s_waitcnt lgkmcnt(4)
  v_mfma_f32_16x16x32_bf16 v[244:247], a[44:47], v[40:43], v[244:247]
  ds_read_b64_tr_b16 v[56:57], v3 offset:50272
  v_mfma_f32_16x16x32_bf16 v[248:251], a[56:59], v[40:43], v[248:251]
  ds_read_b64_tr_b16 v[58:59], v3 offset:52064
  v_mfma_f32_16x16x32_bf16 v[252:255], a[64:67], v[40:43], v[252:255]
  v_mfma_f32_16x16x32_bf16 v[172:175], a[52:55], v[44:47], v[172:175]
  ds_read_b64_tr_b16 v[60:61], v3 offset:50304
  v_mfma_f32_16x16x32_bf16 v[176:179], a[60:63], v[44:47], v[176:179]
  ds_read_b64_tr_b16 v[62:63], v3 offset:52096
  v_mfma_f32_16x16x32_bf16 v[180:183], a[68:71], v[44:47], v[180:183]
  s_waitcnt lgkmcnt(4)
  v_mfma_f32_16x16x32_bf16 v[184:187], a[52:55], v[48:51], v[184:187]
  ds_read_b64_tr_b16 v[40:41], v3 offset:50336
  v_mfma_f32_16x16x32_bf16 v[188:191], a[60:63], v[48:51], v[188:191]
  ds_read_b64_tr_b16 v[42:43], v3 offset:52128
  v_mfma_f32_16x16x32_bf16 v[192:195], a[68:71], v[48:51], v[192:195]
  v_mfma_f32_16x16x32_bf16 v[196:199], a[52:55], v[52:55], v[196:199]
  ds_read_b64_tr_b16 v[44:45], v3 offset:50368
  v_cvt_pk_bf16_f32 v70, v172, v173
  v_mfma_f32_16x16x32_bf16 v[200:203], a[60:63], v[52:55], v[200:203]
  ds_read_b64_tr_b16 v[46:47], v3 offset:52160
  v_cvt_pk_bf16_f32 v71, v174, v175
  v_mfma_f32_16x16x32_bf16 v[204:207], a[68:71], v[52:55], v[204:207]
  s_waitcnt lgkmcnt(4)
  v_cvt_pk_bf16_f32 v72, v176, v177
  v_mfma_f32_16x16x32_bf16 v[208:211], a[52:55], v[56:59], v[208:211]
  v_cvt_pk_bf16_f32 v73, v178, v179
  v_cvt_pk_bf16_f32 v74, v180, v181
  v_mfma_f32_16x16x32_bf16 v[212:215], a[60:63], v[56:59], v[212:215]
  v_cvt_pk_bf16_f32 v75, v182, v183
  v_cvt_pk_bf16_f32 v82, v184, v185
  v_mfma_f32_16x16x32_bf16 v[216:219], a[68:71], v[56:59], v[216:219]
  v_cvt_pk_bf16_f32 v83, v186, v187
  v_cvt_pk_bf16_f32 v84, v188, v189
  v_mfma_f32_16x16x32_bf16 v[220:223], a[52:55], v[60:63], v[220:223]
  v_cvt_pk_bf16_f32 v85, v190, v191
  v_cvt_pk_bf16_f32 v86, v192, v193
  v_mfma_f32_16x16x32_bf16 v[224:227], a[60:63], v[60:63], v[224:227]
  v_cvt_pk_bf16_f32 v87, v194, v195
  v_cvt_pk_bf16_f32 v94, v196, v197
  v_mfma_f32_16x16x32_bf16 v[228:231], a[68:71], v[60:63], v[228:231]
  s_waitcnt lgkmcnt(0)
  v_cvt_pk_bf16_f32 v95, v198, v199
  v_mfma_f32_16x16x32_bf16 v[232:235], a[52:55], v[40:43], v[232:235]
  v_cvt_pk_bf16_f32 v96, v200, v201
  v_cvt_pk_bf16_f32 v97, v202, v203
  v_mfma_f32_16x16x32_bf16 v[236:239], a[60:63], v[40:43], v[236:239]
  v_cvt_pk_bf16_f32 v98, v204, v205
  v_cvt_pk_bf16_f32 v99, v206, v207
  v_mfma_f32_16x16x32_bf16 v[240:243], a[68:71], v[40:43], v[240:243]
  v_cvt_pk_bf16_f32 v106, v208, v209
  v_cvt_pk_bf16_f32 v107, v210, v211
  v_mfma_f32_16x16x32_bf16 v[244:247], a[52:55], v[44:47], v[244:247]
  v_cvt_pk_bf16_f32 v108, v212, v213
  v_cvt_pk_bf16_f32 v109, v214, v215
  v_mfma_f32_16x16x32_bf16 v[248:251], a[60:63], v[44:47], v[248:251]
  v_cvt_pk_bf16_f32 v110, v216, v217
  v_cvt_pk_bf16_f32 v111, v218, v219
  v_mfma_f32_16x16x32_bf16 v[252:255], a[68:71], v[44:47], v[252:255]
  v_cvt_pk_bf16_f32 v118, v220, v221
  v_cvt_pk_bf16_f32 v119, v222, v223
  s_waitcnt vmcnt(11)
  v_mfma_f32_16x16x32_bf16 a[168:171], v[64:67], a[132:135], a[168:171]
  v_cvt_pk_bf16_f32 v120, v224, v225
  v_cvt_pk_bf16_f32 v121, v226, v227
  s_waitcnt vmcnt(9)
  v_mfma_f32_16x16x32_bf16 a[172:175], v[64:67], a[144:147], a[172:175]
  v_cvt_pk_bf16_f32 v122, v228, v229
  v_cvt_pk_bf16_f32 v123, v230, v231
  s_waitcnt vmcnt(7)
  v_mfma_f32_16x16x32_bf16 a[176:179], v[64:67], a[156:159], a[176:179]
  v_cvt_pk_bf16_f32 v130, v232, v233
  v_cvt_pk_bf16_f32 v131, v234, v235
  s_waitcnt vmcnt(5)
  v_mfma_f32_16x16x32_bf16 a[168:171], v[68:71], a[136:139], a[168:171]
  v_cvt_pk_bf16_f32 v132, v236, v237
  v_cvt_pk_bf16_f32 v133, v238, v239
  s_waitcnt vmcnt(3)
  v_mfma_f32_16x16x32_bf16 a[172:175], v[68:71], a[148:151], a[172:175]
  v_cvt_pk_bf16_f32 v134, v240, v241
  v_cvt_pk_bf16_f32 v135, v242, v243
  s_waitcnt vmcnt(1)
  v_mfma_f32_16x16x32_bf16 a[176:179], v[68:71], a[160:163], a[176:179]
  v_cvt_pk_bf16_f32 v142, v244, v245
  v_cvt_pk_bf16_f32 v143, v246, v247
  v_mfma_f32_16x16x32_bf16 a[168:171], v[72:75], a[140:143], a[168:171]
  v_cvt_pk_bf16_f32 v144, v248, v249
  v_cvt_pk_bf16_f32 v145, v250, v251
  v_mfma_f32_16x16x32_bf16 a[172:175], v[72:75], a[152:155], a[172:175]
  v_cvt_pk_bf16_f32 v146, v252, v253
  v_cvt_pk_bf16_f32 v147, v254, v255
  s_waitcnt vmcnt(0)
  v_mfma_f32_16x16x32_bf16 a[176:179], v[72:75], a[164:167], a[176:179]
  v_mfma_f32_16x16x32_bf16 a[180:183], v[76:79], a[132:135], a[180:183]
  v_mfma_f32_16x16x32_bf16 a[184:187], v[76:79], a[144:147], a[184:187]
  v_mfma_f32_16x16x32_bf16 a[188:191], v[76:79], a[156:159], a[188:191]
  v_accvgpr_read_b32 v216, a168
  v_accvgpr_read_b32 v217, a169
  v_mfma_f32_16x16x32_bf16 a[180:183], v[80:83], a[136:139], a[180:183]
  v_accvgpr_read_b32 v218, a170
  v_accvgpr_read_b32 v219, a171
  v_mfma_f32_16x16x32_bf16 a[184:187], v[80:83], a[148:151], a[184:187]
  v_cvt_pk_bf16_f32 v172, v216, v217
  v_cvt_pk_bf16_f32 v173, v218, v219
  v_mfma_f32_16x16x32_bf16 a[188:191], v[80:83], a[160:163], a[188:191]
  v_accvgpr_read_b32 v220, a172
  v_accvgpr_read_b32 v221, a173
  v_mfma_f32_16x16x32_bf16 a[180:183], v[84:87], a[140:143], a[180:183]
  v_accvgpr_read_b32 v222, a174
  v_accvgpr_read_b32 v223, a175
  v_mfma_f32_16x16x32_bf16 a[184:187], v[84:87], a[152:155], a[184:187]
  v_cvt_pk_bf16_f32 v174, v220, v221
  v_cvt_pk_bf16_f32 v175, v222, v223
  v_mfma_f32_16x16x32_bf16 a[188:191], v[84:87], a[164:167], a[188:191]
  buffer_store_dwordx4 v[172:175], v6, s[16:19], 0 offen offset:0 sc1
  v_mfma_f32_16x16x32_bf16 a[192:195], v[88:91], a[132:135], a[192:195]
  ds_write_b128 v16, v[172:175] offset:0
  v_accvgpr_read_b32 v224, a176
  v_mfma_f32_16x16x32_bf16 a[196:199], v[88:91], a[144:147], a[196:199]
  v_accvgpr_read_b32 v225, a177
  v_accvgpr_read_b32 v226, a178
  v_mfma_f32_16x16x32_bf16 a[200:203], v[88:91], a[156:159], a[200:203]
  v_accvgpr_read_b32 v227, a179
  v_cvt_pk_bf16_f32 v176, v224, v225
  v_mfma_f32_16x16x32_bf16 a[192:195], v[92:95], a[136:139], a[192:195]
  v_cvt_pk_bf16_f32 v177, v226, v227
  v_accvgpr_read_b32 v228, a180
  v_mfma_f32_16x16x32_bf16 a[196:199], v[92:95], a[148:151], a[196:199]
  v_accvgpr_read_b32 v229, a181
  v_accvgpr_read_b32 v230, a182
  v_mfma_f32_16x16x32_bf16 a[200:203], v[92:95], a[160:163], a[200:203]
  v_accvgpr_read_b32 v231, a183
  v_cvt_pk_bf16_f32 v178, v228, v229
  v_mfma_f32_16x16x32_bf16 a[192:195], v[96:99], a[140:143], a[192:195]
  v_cvt_pk_bf16_f32 v179, v230, v231
  v_mfma_f32_16x16x32_bf16 a[196:199], v[96:99], a[152:155], a[196:199]
  buffer_store_dwordx4 v[176:179], v6, s[16:19], 0 offen offset:256 sc1
  ds_write_b128 v16, v[176:179] offset:1024
  v_mfma_f32_16x16x32_bf16 a[200:203], v[96:99], a[164:167], a[200:203]
  v_accvgpr_read_b32 v232, a184
  v_accvgpr_read_b32 v233, a185
  v_mfma_f32_16x16x32_bf16 a[204:207], v[100:103], a[132:135], a[204:207]
  v_accvgpr_read_b32 v234, a186
  v_accvgpr_read_b32 v235, a187
  v_mfma_f32_16x16x32_bf16 a[208:211], v[100:103], a[144:147], a[208:211]
  v_cvt_pk_bf16_f32 v180, v232, v233
  v_cvt_pk_bf16_f32 v181, v234, v235
  v_mfma_f32_16x16x32_bf16 a[212:215], v[100:103], a[156:159], a[212:215]
  v_accvgpr_read_b32 v236, a188
  v_accvgpr_read_b32 v237, a189
  v_mfma_f32_16x16x32_bf16 a[204:207], v[104:107], a[136:139], a[204:207]
  v_accvgpr_read_b32 v238, a190
  v_accvgpr_read_b32 v239, a191
  v_cvt_pk_bf16_f32 v182, v236, v237
  v_cvt_pk_bf16_f32 v183, v238, v239
  buffer_store_dwordx4 v[180:183], v6, s[16:19], 0 offen offset:512 sc1
  ds_write_b128 v16, v[180:183] offset:2048
  v_mfma_f32_16x16x32_bf16 a[208:211], v[104:107], a[148:151], a[208:211]
  v_accvgpr_read_b32 v216, a192
  v_accvgpr_read_b32 v217, a193
  v_mfma_f32_16x16x32_bf16 a[212:215], v[104:107], a[160:163], a[212:215]
  v_accvgpr_read_b32 v218, a194
  v_accvgpr_read_b32 v219, a195
  v_mfma_f32_16x16x32_bf16 a[204:207], v[108:111], a[140:143], a[204:207]
  v_cvt_pk_bf16_f32 v184, v216, v217
  v_cvt_pk_bf16_f32 v185, v218, v219
  v_mfma_f32_16x16x32_bf16 a[208:211], v[108:111], a[152:155], a[208:211]
  v_accvgpr_read_b32 v220, a196
  v_accvgpr_read_b32 v221, a197
  v_mfma_f32_16x16x32_bf16 a[212:215], v[108:111], a[164:167], a[212:215]
  v_accvgpr_read_b32 v222, a198
  v_accvgpr_read_b32 v223, a199
  v_mfma_f32_16x16x32_bf16 a[216:219], v[112:115], a[132:135], a[216:219]
  v_cvt_pk_bf16_f32 v186, v220, v221
  v_cvt_pk_bf16_f32 v187, v222, v223
  buffer_store_dwordx4 v[184:187], v6, s[16:19], 0 offen offset:768 sc1
  ds_write_b128 v16, v[184:187] offset:3072
  v_mfma_f32_16x16x32_bf16 a[220:223], v[112:115], a[144:147], a[220:223]
  v_accvgpr_read_b32 v224, a200
  v_accvgpr_read_b32 v225, a201
  v_mfma_f32_16x16x32_bf16 a[224:227], v[112:115], a[156:159], a[224:227]
  v_accvgpr_read_b32 v226, a202
  v_accvgpr_read_b32 v227, a203
  v_mfma_f32_16x16x32_bf16 a[216:219], v[116:119], a[136:139], a[216:219]
  v_cvt_pk_bf16_f32 v188, v224, v225
  v_cvt_pk_bf16_f32 v189, v226, v227
  v_mfma_f32_16x16x32_bf16 a[220:223], v[116:119], a[148:151], a[220:223]
  v_accvgpr_read_b32 v228, a204
  v_accvgpr_read_b32 v229, a205
  v_mfma_f32_16x16x32_bf16 a[224:227], v[116:119], a[160:163], a[224:227]
  v_accvgpr_read_b32 v230, a206
  v_accvgpr_read_b32 v231, a207
  v_mfma_f32_16x16x32_bf16 a[216:219], v[120:123], a[140:143], a[216:219]
  v_cvt_pk_bf16_f32 v190, v228, v229
  v_cvt_pk_bf16_f32 v191, v230, v231
  v_mfma_f32_16x16x32_bf16 a[220:223], v[120:123], a[152:155], a[220:223]
  buffer_store_dwordx4 v[188:191], v6, s[16:19], 0 offen offset:1024 sc1
  ds_write_b128 v16, v[188:191] offset:4096
  v_mfma_f32_16x16x32_bf16 a[224:227], v[120:123], a[164:167], a[224:227]
  v_accvgpr_read_b32 v232, a208
  v_accvgpr_read_b32 v233, a209
  v_mfma_f32_16x16x32_bf16 a[228:231], v[124:127], a[132:135], a[228:231]
  v_accvgpr_read_b32 v234, a210
  v_accvgpr_read_b32 v235, a211
  v_mfma_f32_16x16x32_bf16 a[232:235], v[124:127], a[144:147], a[232:235]
  v_cvt_pk_bf16_f32 v192, v232, v233
  v_cvt_pk_bf16_f32 v193, v234, v235
  v_mfma_f32_16x16x32_bf16 a[236:239], v[124:127], a[156:159], a[236:239]
  v_accvgpr_read_b32 v236, a212
  v_accvgpr_read_b32 v237, a213
  v_mfma_f32_16x16x32_bf16 a[228:231], v[128:131], a[136:139], a[228:231]
  v_accvgpr_read_b32 v238, a214
  v_accvgpr_read_b32 v239, a215
  v_cvt_pk_bf16_f32 v194, v236, v237
  v_cvt_pk_bf16_f32 v195, v238, v239
  buffer_store_dwordx4 v[192:195], v6, s[16:19], 0 offen offset:1280 sc1
  ds_write_b128 v16, v[192:195] offset:5120
  v_mfma_f32_16x16x32_bf16 a[232:235], v[128:131], a[148:151], a[232:235]
  v_accvgpr_read_b32 v216, a216
  v_accvgpr_read_b32 v217, a217
  v_mfma_f32_16x16x32_bf16 a[236:239], v[128:131], a[160:163], a[236:239]
  v_accvgpr_read_b32 v218, a218
  v_accvgpr_read_b32 v219, a219
  v_mfma_f32_16x16x32_bf16 a[228:231], v[132:135], a[140:143], a[228:231]
  v_cvt_pk_bf16_f32 v196, v216, v217
  v_cvt_pk_bf16_f32 v197, v218, v219
  v_mfma_f32_16x16x32_bf16 a[232:235], v[132:135], a[152:155], a[232:235]
  v_accvgpr_read_b32 v220, a220
  v_accvgpr_read_b32 v221, a221
  v_mfma_f32_16x16x32_bf16 a[236:239], v[132:135], a[164:167], a[236:239]
  v_accvgpr_read_b32 v222, a222
  v_accvgpr_read_b32 v223, a223
  v_mfma_f32_16x16x32_bf16 a[240:243], v[136:139], a[132:135], a[240:243]
  v_cvt_pk_bf16_f32 v198, v220, v221
  v_cvt_pk_bf16_f32 v199, v222, v223
  buffer_store_dwordx4 v[196:199], v6, s[16:19], 0 offen offset:1536 sc1
  ds_write_b128 v16, v[196:199] offset:6144
  v_mfma_f32_16x16x32_bf16 a[244:247], v[136:139], a[144:147], a[244:247]
  v_accvgpr_read_b32 v224, a224
  v_accvgpr_read_b32 v225, a225
  v_mfma_f32_16x16x32_bf16 a[248:251], v[136:139], a[156:159], a[248:251]
  v_accvgpr_read_b32 v226, a226
  v_accvgpr_read_b32 v227, a227
  v_mfma_f32_16x16x32_bf16 a[240:243], v[140:143], a[136:139], a[240:243]
  v_cvt_pk_bf16_f32 v200, v224, v225
  v_cvt_pk_bf16_f32 v201, v226, v227
  v_mfma_f32_16x16x32_bf16 a[244:247], v[140:143], a[148:151], a[244:247]
  v_accvgpr_read_b32 v228, a228
  v_accvgpr_read_b32 v229, a229
  v_mfma_f32_16x16x32_bf16 a[248:251], v[140:143], a[160:163], a[248:251]
  v_accvgpr_read_b32 v230, a230
  v_accvgpr_read_b32 v231, a231
  v_mfma_f32_16x16x32_bf16 a[240:243], v[144:147], a[140:143], a[240:243]
  v_cvt_pk_bf16_f32 v202, v228, v229
  v_cvt_pk_bf16_f32 v203, v230, v231
  v_mfma_f32_16x16x32_bf16 a[244:247], v[144:147], a[152:155], a[244:247]
  buffer_store_dwordx4 v[200:203], v6, s[16:19], 0 offen offset:1792 sc1
  ds_write_b128 v16, v[200:203] offset:7168
  v_mfma_f32_16x16x32_bf16 a[248:251], v[144:147], a[164:167], a[248:251]
  v_accvgpr_read_b32 v232, a232
  v_accvgpr_read_b32 v233, a233
  v_accvgpr_read_b32 v234, a234
  v_accvgpr_read_b32 v235, a235
  v_cvt_pk_bf16_f32 v204, v232, v233
  v_cvt_pk_bf16_f32 v205, v234, v235
  v_accvgpr_read_b32 v236, a236
  v_accvgpr_read_b32 v237, a237
  v_accvgpr_read_b32 v238, a238
  v_accvgpr_read_b32 v239, a239
  v_cvt_pk_bf16_f32 v206, v236, v237
  v_cvt_pk_bf16_f32 v207, v238, v239
  buffer_store_dwordx4 v[204:207], v6, s[16:19], 0 offen offset:2048 sc1
  ds_write_b128 v16, v[204:207] offset:8192
  v_accvgpr_read_b32 v216, a240
  v_accvgpr_read_b32 v217, a241
  v_accvgpr_read_b32 v218, a242
  v_accvgpr_read_b32 v219, a243
  v_cvt_pk_bf16_f32 v208, v216, v217
  v_cvt_pk_bf16_f32 v209, v218, v219
  v_accvgpr_read_b32 v220, a244
  v_accvgpr_read_b32 v221, a245
  v_accvgpr_read_b32 v222, a246
  v_accvgpr_read_b32 v223, a247
  v_cvt_pk_bf16_f32 v210, v220, v221
  v_cvt_pk_bf16_f32 v211, v222, v223
  buffer_store_dwordx4 v[208:211], v6, s[16:19], 0 offen offset:2304 sc1
  ds_write_b128 v16, v[208:211] offset:9216
  v_accvgpr_read_b32 v224, a248
  v_accvgpr_read_b32 v225, a249
  v_accvgpr_read_b32 v226, a250
  v_accvgpr_read_b32 v227, a251
  v_cvt_pk_bf16_f32 v212, v224, v225
  v_cvt_pk_bf16_f32 v213, v226, v227
  buffer_store_dwordx4 v[212:215], v6, s[16:19], 0 offen offset:2560 sc1
  ds_write_b128 v16, v[212:215] offset:10240
  v_mov_b32 v39, s57
  s_lshl_b32 s31, s20, 7
  s_waitcnt vmcnt(0)
  s_mov_b64 exec, 1
  buffer_store_dword v39, v8, s[16:19], s31 offen sc1
  s_mov_b64 exec, -1
  s_nop 1
  buffer_load_dword v39, v8, s[16:19], 0 offen sc1
  s_waitcnt lgkmcnt(0)
  ds_read_b128 v[216:219], v17 offset:0
  ds_read_b128 v[220:223], v17 offset:4096
  ds_read_b128 v[224:227], v17 offset:8192
  s_add_u32 s80, s20, 1
  s_and_b32 s80, s80, 3
  s_mul_i32 s80, s80, 3072
  s_add_u32 s81, s20, 2
  s_and_b32 s81, s81, 3
  s_mul_i32 s81, s81, 3072
  s_add_u32 s82, s20, 3
  s_and_b32 s82, s82, 3
  s_mul_i32 s82, s82, 3072
  s_mov_b32 s84, 0x3f80
  s_mov_b32 s85, 0x3f800000
  s_waitcnt lgkmcnt(2)
  v_lshlrev_b32 v228, 16, v216
  v_and_b32 v229, 0xffff0000, v216
  v_lshlrev_b32 v230, 16, v217
  v_and_b32 v231, 0xffff0000, v217
  v_lshlrev_b32 v232, 16, v218
  v_and_b32 v233, 0xffff0000, v218
  v_lshlrev_b32 v234, 16, v219
  v_and_b32 v235, 0xffff0000, v219
  s_waitcnt lgkmcnt(1)
  v_lshlrev_b32 v236, 16, v220
  v_and_b32 v237, 0xffff0000, v220
  v_lshlrev_b32 v238, 16, v221
  v_and_b32 v239, 0xffff0000, v221
  v_lshlrev_b32 v240, 16, v222
  v_and_b32 v241, 0xffff0000, v222
  v_lshlrev_b32 v242, 16, v223
  v_and_b32 v243, 0xffff0000, v223
  s_waitcnt lgkmcnt(0)
  v_lshlrev_b32 v244, 16, v224
  v_and_b32 v245, 0xffff0000, v224
  v_lshlrev_b32 v246, 16, v225
  v_and_b32 v247, 0xffff0000, v225
  v_lshlrev_b32 v248, 16, v226
  v_and_b32 v249, 0xffff0000, v226
  v_lshlrev_b32 v250, 16, v227
  v_and_b32 v251, 0xffff0000, v227
  s_waitcnt vmcnt(0)
  v_cmp_ne_u32 vcc, s57, v39
  s_nop 1
  s_cmp_eq_u64 vcc, 0
  s_cbranch_scc0 Lf2
Lf2_r:
  buffer_load_dwordx4 v[64:67], v9, s[16:19], s80 offen offset:0 sc1
  buffer_load_dwordx4 v[68:71], v9, s[16:19], s81 offen offset:0 sc1
  buffer_load_dwordx4 v[72:75], v9, s[16:19], s82 offen offset:0 sc1
  buffer_load_dwordx4 v[76:79], v9, s[16:19], s80 offen offset:1024 sc1
  buffer_load_dwordx4 v[80:83], v9, s[16:19], s81 offen offset:1024 sc1
  buffer_load_dwordx4 v[84:87], v9, s[16:19], s82 offen offset:1024 sc1
  buffer_load_dwordx4 v[88:91], v9, s[16:19], s80 offen offset:2048 sc1
  buffer_load_dwordx4 v[92:95], v9, s[16:19], s81 offen offset:2048 sc1
  buffer_load_dwordx4 v[96:99], v9, s[16:19], s82 offen offset:2048 sc1
  s_waitcnt vmcnt(8)
  v_dot2c_f32_bf16 v228, s84, v64
  v_dot2c_f32_bf16 v229, s85, v64
  v_dot2c_f32_bf16 v230, s84, v65
  v_dot2c_f32_bf16 v231, s85, v65
  v_dot2c_f32_bf16 v232, s84, v66
  v_dot2c_f32_bf16 v233, s85, v66
  v_dot2c_f32_bf16 v234, s84, v67
  v_dot2c_f32_bf16 v235, s85, v67
  s_waitcnt vmcnt(7)
  v_dot2c_f32_bf16 v228, s84, v68
  v_dot2c_f32_bf16 v229, s85, v68
  v_dot2c_f32_bf16 v230, s84, v69
  v_dot2c_f32_bf16 v231, s85, v69
  v_dot2c_f32_bf16 v232, s84, v70
  v_dot2c_f32_bf16 v233, s85, v70
  v_dot2c_f32_bf16 v234, s84, v71
  v_dot2c_f32_bf16 v235, s85, v71
  s_waitcnt vmcnt(6)
  v_dot2c_f32_bf16 v228, s84, v72
  v_dot2c_f32_bf16 v229, s85, v72
  v_dot2c_f32_bf16 v230, s84, v73
  v_dot2c_f32_bf16 v231, s85, v73
  v_dot2c_f32_bf16 v232, s84, v74
  v_dot2c_f32_bf16 v233, s85, v74
  v_dot2c_f32_bf16 v234, s84, v75
  v_dot2c_f32_bf16 v235, s85, v75
  v_cvt_pk_bf16_f32 v216, v228, v229
  v_cvt_pk_bf16_f32 v217, v230, v231
  v_cvt_pk_bf16_f32 v218, v232, v233
  v_cvt_pk_bf16_f32 v219, v234, v235
  buffer_store_dwordx2 v[216:217], v10, s[72:75], 0 offen
  buffer_store_dwordx2 v[218:219], v11, s[72:75], 0 offen
  s_waitcnt vmcnt(7)
  v_dot2c_f32_bf16 v236, s84, v76
  v_dot2c_f32_bf16 v237, s85, v76
  v_dot2c_f32_bf16 v238, s84, v77
  v_dot2c_f32_bf16 v239, s85, v77
  v_dot2c_f32_bf16 v240, s84, v78
  v_dot2c_f32_bf16 v241, s85, v78
  v_dot2c_f32_bf16 v242, s84, v79
  v_dot2c_f32_bf16 v243, s85, v79
  s_waitcnt vmcnt(6)
  v_dot2c_f32_bf16 v236, s84, v80
  v_dot2c_f32_bf16 v237, s85, v80
  v_dot2c_f32_bf16 v238, s84, v81
  v_dot2c_f32_bf16 v239, s85, v81
  v_dot2c_f32_bf16 v240, s84, v82
  v_dot2c_f32_bf16 v241, s85, v82
  v_dot2c_f32_bf16 v242, s84, v83
  v_dot2c_f32_bf16 v243, s85, v83
  s_waitcnt vmcnt(5)
  v_dot2c_f32_bf16 v236, s84, v84
  v_dot2c_f32_bf16 v237, s85, v84
  v_dot2c_f32_bf16 v238, s84, v85
  v_dot2c_f32_bf16 v239, s85, v85
  v_dot2c_f32_bf16 v240, s84, v86
  v_dot2c_f32_bf16 v241, s85, v86
  v_dot2c_f32_bf16 v242, s84, v87
  v_dot2c_f32_bf16 v243, s85, v87
  v_cvt_pk_bf16_f32 v220, v236, v237
  v_cvt_pk_bf16_f32 v221, v238, v239
  v_cvt_pk_bf16_f32 v222, v240, v241
  v_cvt_pk_bf16_f32 v223, v242, v243
  buffer_store_dwordx2 v[220:221], v12, s[72:75], 0 offen
  buffer_store_dwordx2 v[222:223], v13, s[72:75], 0 offen
  s_waitcnt vmcnt(6)
  v_dot2c_f32_bf16 v244, s84, v88
  v_dot2c_f32_bf16 v245, s85, v88
  v_dot2c_f32_bf16 v246, s84, v89
  v_dot2c_f32_bf16 v247, s85, v89
  v_dot2c_f32_bf16 v248, s84, v90
  v_dot2c_f32_bf16 v249, s85, v90
  v_dot2c_f32_bf16 v250, s84, v91
  v_dot2c_f32_bf16 v251, s85, v91
  s_waitcnt vmcnt(5)
  v_dot2c_f32_bf16 v244, s84, v92
  v_dot2c_f32_bf16 v245, s85, v92
  v_dot2c_f32_bf16 v246, s84, v93
  v_dot2c_f32_bf16 v247, s85, v93
  v_dot2c_f32_bf16 v248, s84, v94
  v_dot2c_f32_bf16 v249, s85, v94
  v_dot2c_f32_bf16 v250, s84, v95
  v_dot2c_f32_bf16 v251, s85, v95
  s_waitcnt vmcnt(4)
  v_dot2c_f32_bf16 v244, s84, v96
  v_dot2c_f32_bf16 v245, s85, v96
  v_dot2c_f32_bf16 v246, s84, v97
  v_dot2c_f32_bf16 v247, s85, v97
  v_dot2c_f32_bf16 v248, s84, v98
  v_dot2c_f32_bf16 v249, s85, v98
  v_dot2c_f32_bf16 v250, s84, v99
  v_dot2c_f32_bf16 v251, s85, v99
  v_cvt_pk_bf16_f32 v224, v244, v245
  v_cvt_pk_bf16_f32 v225, v246, v247
  v_cvt_pk_bf16_f32 v226, v248, v249
  v_cvt_pk_bf16_f32 v227, v250, v251
  buffer_store_dwordx2 v[224:225], v14, s[72:75], 0 offen
  buffer_store_dwordx2 v[226:227], v15, s[72:75], 0 offen
Lend:
  s_endpgm
Ltag:
  s_mov_b32 s62, 0x40000
Ltag_l:
  s_sleep 2
  buffer_load_dword v39, off, s[76:79], 0 sc1
  s_waitcnt vmcnt(0)
  v_cmp_eq_u32 vcc, 0, v39
  s_nop 4
  s_cmp_eq_u64 vcc, 0
  s_cbranch_scc1 Ltag_r
  s_sub_u32 s62, s62, 1
  s_cmp_lg_u32 s62, 0
  s_cbranch_scc1 Ltag_l
  s_branch Ltag_r
Lf1:
  s_mov_b32 s62, 0x40000
Lf1_l:
  s_sleep 2
  buffer_load_dword v39, v7, s[16:19], 0 offen sc1
  s_waitcnt vmcnt(0)
  v_cmp_ne_u32 vcc, s57, v39
  s_nop 4
  s_cmp_eq_u64 vcc, 0
  s_cbranch_scc1 Lf1_r
  s_sub_u32 s62, s62, 1
  s_cmp_lg_u32 s62, 0
  s_cbranch_scc1 Lf1_l
  s_branch Lf1_r
Lf2:
  s_mov_b32 s62, 0x40000
  s_waitcnt vmcnt(0)
  buffer_load_dword v39, v8, s[16:19], 0 offen sc1
  s_sleep 4
Lf2_l:
  buffer_load_dword v7, v8, s[16:19], 0 offen sc1
  s_waitcnt vmcnt(1)
  v_cmp_ne_u32 vcc, s57, v39
  s_nop 4
  s_cmp_eq_u64 vcc, 0
  s_cbranch_scc1 Lf2_r
  buffer_load_dword v39, v8, s[16:19], 0 offen sc1
  s_waitcnt vmcnt(1)
  v_cmp_ne_u32 vcc, s57, v7
  s_nop 4
  s_cmp_eq_u64 vcc, 0
  s_cbranch_scc1 Lf2_r
  s_sub_u32 s62, s62, 1
  s_cmp_lg_u32 s62, 0
  s_cbranch_scc1 Lf2_l
  s_branch Lf2_r
Lcodeend:
.section .rodata,"a"
.p2align 6
.amdhsa_kernel concat_heads__mha_block_cached__gqa_block_cached__near_ridge_kernel
  .amdhsa_next_free_vgpr 512
  .amdhsa_next_free_sgpr 102
  .amdhsa_accum_offset 256
  .amdhsa_group_segment_fixed_size 0
  .amdhsa_kernarg_size 104
  .amdhsa_user_sgpr_count 2
  .amdhsa_user_sgpr_kernarg_segment_ptr 1
  .amdhsa_system_sgpr_workgroup_id_x 1
.end_amdhsa_kernel
```
